```python
import torch

def _softmax(x, axis=-1):
    return torch.softmax(x, dim=axis)
def _gelu(x):
    return torch.nn.functional.gelu(x, approximate="tanh")
def _silu(x):
    return torch.nn.functional.silu(x)
def _sigmoid(x):
    return torch.sigmoid(x)
def _layernorm(x, axis=-1, eps=1e-5):
    m = x.mean(dim=axis, keepdim=True)
    v = x.var(dim=axis, keepdim=True, unbiased=False)
    return (x - m) / torch.sqrt(v + eps)
def _scatter_add(tgt, idx, src, axis=0):
    return tgt.clone().index_add_(axis, idx, src)
def _segment_sum(src, seg, n):
    out = torch.zeros((n,) + src.shape[1:], dtype=src.dtype)
    return out.index_add_(0, seg, src)
def _pad(x, pw):
    flat = tuple(v for pair in reversed(pw) for v in pair)
    return torch.nn.functional.pad(x, flat)

kernel_name = 'standalone__kv_cache_quant_int4_int2_kv_with_per_channel_or_per_token_scales__decode'

def setup_inputs():

    _w = (lambda a: (lambda t: t.to(torch.bfloat16) if t.is_floating_point() else t)(torch.as_tensor(a)))
    B = 2
    Sq = 1
    Skv = 32768
    Hq = 32
    Hkv = 4
    Dh = 128
    bits = 3
    G = 128
    if G <= 0 or G >= Skv:
        G = max(1, Skv // 2)
    Skv = (Skv // G) * G
    ngk = Skv // G
    qmax = (1 << bits) - 1
    return {
        "q": _w((lambda *s: torch.randn(*s, dtype=torch.bfloat16) * 1.6)(B, Hq, Sq, Dh)),
        "qk": _w(torch.randint(0, qmax + 1, (B, Hkv, Skv, Dh)).to(torch.int32)),
        "qv": _w(torch.randint(0, qmax + 1, (B, Hkv, Skv, Dh)).to(torch.int32)),
        "k_scales": _w(torch.abs((lambda *s: torch.randn(*s, dtype=torch.bfloat16) * 1.6)(B, Hkv, ngk, Dh)) * 0.05 + 0.02),
        "k_zeros": _w((lambda *s: torch.randn(*s, dtype=torch.bfloat16) * 1.6)(B, Hkv, ngk, Dh) + float(qmax) / 2.0),
        "v_scales": _w(torch.abs((lambda *s: torch.randn(*s, dtype=torch.bfloat16) * 0.05)(B, Hkv, Skv, 1)) * 0.05 + 0.02),
        "v_zeros": _w((lambda *s: torch.randn(*s, dtype=torch.bfloat16) * 0.05)(B, Hkv, Skv, 1) + float(qmax) / 2.0),
    }

def reference(q, qk, qv, k_scales, k_zeros, v_scales, v_zeros):
    B, Hq, Sq, Dh = q.shape
    Hkv, Skv = qk.shape[1], qk.shape[2]
    ngk = k_scales.shape[2]
    G = Skv // ngk
    ks = (lambda x, n, axis: torch.repeat_interleave(x, n, dim=axis))(k_scales, G, axis=2)
    kz = (lambda x, n, axis: torch.repeat_interleave(x, n, dim=axis))(k_zeros, G, axis=2)
    k = ((lambda x, dt: x.to(dt))(qk, q.dtype) - kz) * ks
    v = ((lambda x, dt: x.to(dt))(qv, q.dtype) - v_zeros) * v_scales
    rep = Hq // Hkv
    if rep > 1:
        k = (lambda x, n, axis: torch.repeat_interleave(x, n, dim=axis))(k, rep, axis=1)
        v = (lambda x, n, axis: torch.repeat_interleave(x, n, dim=axis))(v, rep, axis=1)
    scale = float(Dh) ** -0.5
    logits = torch.einsum("bhqd,bhkd->bhqk", q, k) * scale
    p = _softmax(logits, axis=-1)
    o = torch.einsum("bhqk,bhkd->bhqd", p, v)
    return o
```

```asm
; @launch grid=(256,1,1) block=(576,1,1) lds=106048
.amdgcn_target "amdgcn-amd-amdhsa--gfx950"
.text
.globl standalone__kv_cache_quant_int4_int2_kv_with_per_channel_or_per_token_scales__decode_kernel
.p2align 8
.type standalone__kv_cache_quant_int4_int2_kv_with_per_channel_or_per_token_scales__decode_kernel,@function
standalone__kv_cache_quant_int4_int2_kv_with_per_channel_or_per_token_scales__decode_kernel:
    s_cmp_ge_u32 s2, 256
    s_cbranch_scc1 L_done
    s_load_dwordx16 s[16:31], s[0:1], 0
    s_load_dwordx4 s[32:35], s[0:1], 64
    v_lshrrev_b32 v1, 6, v0
    v_and_b32 v57, 63, v0
    v_readfirstlane_b32 s3, v1
    s_bfe_i32 s37, s2, 0x10000
    s_and_b32 s38, s37, 0x3ca2700
    s_bfe_i32 s37, s2, 0x10001
    s_and_b32 s37, s37, 0x3fe0400
    s_xor_b32 s38, s38, s37
    s_bfe_i32 s37, s2, 0x10002
    s_and_b32 s37, s37, 0x7f01b00
    s_xor_b32 s38, s38, s37
    s_bfe_i32 s37, s2, 0x10003
    s_and_b32 s37, s37, 0x1ee2500
    s_xor_b32 s38, s38, s37
    s_bfe_i32 s37, s2, 0x10004
    s_and_b32 s37, s37, 0x1ec1700
    s_xor_b32 s38, s38, s37
    s_bfe_i32 s37, s2, 0x10005
    s_and_b32 s37, s37, 0x4000200
    s_xor_b32 s38, s38, s37
    s_bfe_i32 s37, s2, 0x10006
    s_and_b32 s37, s37, 0x4101400
    s_xor_b32 s38, s38, s37
    s_bfe_i32 s37, s2, 0x10007
    s_and_b32 s37, s37, 0x2143900
    s_xor_b32 s38, s38, s37
    s_cmp_eq_u32 s3, 8
    s_cbranch_scc1 L_helper
    s_bfe_i32 s37, s3, 0x10000
    s_and_b32 s37, s37, 0x6a00
    s_xor_b32 s38, s38, s37
    s_bfe_i32 s37, s3, 0x10001
    s_and_b32 s37, s37, 0x8b00
    s_xor_b32 s38, s38, s37
    s_bfe_i32 s37, s3, 0x10002
    s_and_b32 s37, s37, 0x11000
    s_xor_b32 s38, s38, s37
    v_and_b32 v2, 31, v57
    v_lshrrev_b32 v58, 5, v57
    v_lshlrev_b32 v2, 4, v2
    v_lshl_or_b32 v2, v58, 12, v2
    s_and_b32 s39, s38, 0x1000
    v_xor_b32 v2, s39, v2
    s_and_b32 s40, s38, 0x7ffee00
    s_mov_b32 s10, 0x8000000
    s_mov_b32 s11, 0x20000
    s_waitcnt lgkmcnt(0)
    s_mov_b32 s8, s18
    s_mov_b32 s9, s19
    s_xor_b32 s42, s40, 0x0
    buffer_load_dwordx4 v[128:131], v2, s[8:11], s42 offen nt
    s_xor_b32 s42, s40, 0x400
    buffer_load_dwordx4 v[132:135], v2, s[8:11], s42 offen nt
    s_xor_b32 s42, s40, 0x200
    buffer_load_dwordx4 v[136:139], v2, s[8:11], s42 offen nt
    s_lshr_b32 s4, s38, 24
    s_bfe_u32 s5, s38, 0x50011
    s_bfe_u32 s47, s38, 0x20016
    v_lshlrev_b32 v19, 4, v57
    v_mul_u32_u24 v4, 288, v58
    v_and_b32 v58, 15, v57
    v_lshrrev_b32 v59, 4, v57
    s_lshr_b32 s7, s3, 1
    s_xor_b32 s7, s7, s47
    s_lshl_b32 s7, s7, 6
    s_lshl_b32 s36, s5, 1
    s_add_u32 s7, s7, s36
    s_and_b32 s36, s3, 1
    s_add_u32 s7, s7, s36
    s_lshl_b32 s36, s4, 11
    v_add_u32 v80, s36, v19
    s_lshl_b32 s36, s4, 8
    s_add_u32 s36, s36, s7
    s_lshl_b32 s36, s36, 8
    v_lshl_add_u32 v81, v58, 4, s36
    global_load_dwordx4 v[64:67], v80, s[16:17]
    global_load_dwordx4 v[68:71], v80, s[16:17] offset:1024
    global_load_dwordx4 v[72:75], v81, s[22:23] nt
    global_load_dwordx4 v[76:79], v81, s[24:25] nt
    s_and_b32 s36, s38, 0x7ffc000
    s_lshr_b32 s36, s36, 8
    v_lshlrev_b32 v12, 14, v59
    v_lshl_add_u32 v12, v58, 2, v12
    v_xor_b32 v12, s36, v12
    s_mul_i32 s36, s3, 9216
    v_and_b32 v5, 31, v57
    v_lshl_add_u32 v4, v5, 3, v4
    v_add_u32 v4, s36, v4
    v_mul_u32_u24 v5, 288, v58
    v_lshl_add_u32 v5, v59, 4, v5
    v_add_u32 v5, s36, v5
    s_and_b32 s37, s38, 0x100
    s_add_u32 s36, s36, s37
    v_mul_u32_u24 v160, 528, v58
    v_lshl_add_u32 v160, v59, 6, v160
    v_add_u32 v160, s36, v160
    s_lshl_b32 s37, s37, 1
    s_sub_u32 s37, 256, s37
    v_add_u32 v161, s37, v160
    s_mov_b32 s52, s34
    s_mov_b32 s53, s35
    s_mov_b32 s54, 1114368
    s_mov_b32 s55, 0x20000
    s_lshl_b32 s36, s4, 5
    s_add_u32 s36, s36, s5
    s_mul_i32 s56, s36, 4352
    s_mov_b32 s12, s20
    s_mov_b32 s13, s21
    s_mov_b32 s14, 0x8000000
    s_mov_b32 s15, 0x20000
    s_and_b32 s41, s38, 0x7ffdd00
    v_and_b32 v10, 1, v59
    v_lshrrev_b32 v11, 1, v59
    v_lshlrev_b32 v3, 4, v58
    v_lshl_or_b32 v3, v10, 13, v3
    v_lshl_or_b32 v3, v11, 9, v3
    s_and_b32 s39, s38, 0x2200
    v_xor_b32 v3, s39, v3
    s_lshl_b32 s36, s3, 4
    s_add_u32 s36, s36, 104448
    v_and_b32 v6, 7, v58
    v_lshl_add_u32 v162, v6, 7, s36
    s_lshr_b32 s37, s3, 2
    s_mul_i32 s36, s37, 2816
    s_add_u32 s36, s36, 73728
    v_mul_u32_u24 v6, 352, v6
    v_lshl_add_u32 v6, v59, 4, v6
    v_add_u32 v6, s36, v6
    s_mul_i32 s36, s3, 2816
    s_add_u32 s36, s36, 73728
    v_mul_u32_u24 v15, 352, v59
    v_lshl_add_u32 v15, v58, 4, v15
    v_add_u32 v15, s36, v15
    s_lshl_b32 s36, s3, 10
    s_add_u32 s36, s36, 96256
    v_lshl_add_u32 v7, v59, 6, s36
    s_bfe_u32 s39, s38, 0x50009
    v_lshlrev_b32 v11, 1, v58
    v_xor_b32 v11, s39, v11
    v_lshl_add_u32 v28, v59, 8, s36
    v_mov_b32 v29, 0
    v_bfe_u32 v10, v11, 0, 1
    v_lshl_add_u32 v28, v10, 7, v28
    v_bfe_u32 v10, v11, 1, 1
    v_lshl_add_u32 v29, v10, 3, v29
    v_bfe_u32 v10, v11, 2, 1
    v_lshl_add_u32 v29, v10, 2, v29
    v_bfe_u32 v10, v11, 3, 1
    v_lshl_add_u32 v29, v10, 1, v29
    v_bfe_u32 v10, v11, 4, 1
    v_lshl_add_u32 v28, v10, 6, v28
    v_add_u32 v30, v28, v29
    v_lshl_add_u32 v28, v29, 1, v28
    v_xor_b32 v29, 128, v28
    v_xor_b32 v31, 128, v30
    v_lshrrev_b32 v10, 5, v0
    v_and_b32 v11, 31, v0
    v_mul_u32_u24 v163, 528, v10
    v_lshl_add_u32 v163, v11, 4, v163
    v_lshlrev_b32 v164, 6, v10
    v_add_u32 v164, 105472, v164
    v_and_b32 v11, 3, v0
    v_lshl_add_u32 v1, v11, 2, v164
    v_lshlrev_b32 v165, 4, v0
    v_mov_b32 v166, 105984
    v_mov_b32 v167, 1
    s_mov_b32 s44, 0x3e0293ee
    s_mov_b32 s45, 0xffff0000
    s_mov_b32 s57, 0x07060503
    s_mov_b32 s58, 0x07060502
    s_mov_b32 s59, 0x07060501
    v_mov_b32 v8, 0xff800000
    v_mov_b32 v9, 0
    s_waitcnt vmcnt(6)
    s_xor_b32 s42, s40, 0x600
    buffer_load_dwordx4 v[140:143], v2, s[8:11], s42 offen nt
    v_cvt_f32_i32 v128, v128
    v_cvt_f32_i32 v129, v129
    v_cvt_f32_i32 v130, v130
    v_cvt_f32_i32 v131, v131
    v_cvt_pk_bf16_f32 v60, v128, v129
    v_cvt_pk_bf16_f32 v61, v130, v131
    ds_write_b64 v4, v[60:61] offset:0
    s_waitcnt vmcnt(6)
    s_xor_b32 s42, s40, 0x800
    buffer_load_dwordx4 v[144:147], v2, s[8:11], s42 offen nt
    v_cvt_f32_i32 v132, v132
    v_cvt_f32_i32 v133, v133
    v_cvt_f32_i32 v134, v134
    v_cvt_f32_i32 v135, v135
    v_cvt_pk_bf16_f32 v62, v132, v133
    v_cvt_pk_bf16_f32 v63, v134, v135
    ds_write_b64 v4, v[62:63] offset:4608
    s_waitcnt vmcnt(6)
    s_xor_b32 s42, s40, 0xc00
    buffer_load_dwordx4 v[148:151], v2, s[8:11], s42 offen nt
    v_cvt_f32_i32 v136, v136
    v_cvt_f32_i32 v137, v137
    v_cvt_f32_i32 v138, v138
    v_cvt_f32_i32 v139, v139
    v_cvt_pk_bf16_f32 v60, v136, v137
    v_cvt_pk_bf16_f32 v61, v138, v139
    ds_write_b64 v4, v[60:61] offset:2304
    s_waitcnt vmcnt(2)
    s_xor_b32 s42, s40, 0xa00
    buffer_load_dwordx4 v[152:155], v2, s[8:11], s42 offen nt
    v_cvt_f32_i32 v140, v140
    v_cvt_f32_i32 v141, v141
    v_cvt_f32_i32 v142, v142
    v_cvt_f32_i32 v143, v143
    v_cvt_pk_bf16_f32 v62, v140, v141
    v_cvt_pk_bf16_f32 v63, v142, v143
    ds_write_b64 v4, v[62:63] offset:6912
    v_lshlrev_b32 v20, 16, v72
    v_and_b32 v21, s45, v72
    v_mul_f32 v20, s44, v20
    v_mul_f32 v21, s44, v21
    v_lshlrev_b32 v22, 16, v64
    v_and_b32 v23, s45, v64
    v_mul_f32 v22, v22, v20
    v_mul_f32 v23, v23, v21
    v_cvt_pk_bf16_f32 v40, v22, v23
    v_lshlrev_b32 v22, 16, v68
    v_and_b32 v23, s45, v68
    v_mul_f32 v22, v22, v20
    v_mul_f32 v23, v23, v21
    v_cvt_pk_bf16_f32 v44, v22, v23
    v_lshlrev_b32 v20, 16, v73
    v_and_b32 v21, s45, v73
    v_mul_f32 v20, s44, v20
    v_mul_f32 v21, s44, v21
    v_lshlrev_b32 v22, 16, v65
    v_and_b32 v23, s45, v65
    v_mul_f32 v22, v22, v20
    v_mul_f32 v23, v23, v21
    v_cvt_pk_bf16_f32 v41, v22, v23
    v_lshlrev_b32 v22, 16, v69
    v_and_b32 v23, s45, v69
    v_mul_f32 v22, v22, v20
    v_mul_f32 v23, v23, v21
    v_cvt_pk_bf16_f32 v45, v22, v23
    s_waitcnt vmcnt(2)
    s_xor_b32 s42, s40, 0xe00
    buffer_load_dwordx4 v[156:159], v2, s[8:11], s42 offen nt
    v_cvt_f32_i32 v144, v144
    v_cvt_f32_i32 v145, v145
    v_cvt_f32_i32 v146, v146
    v_cvt_f32_i32 v147, v147
    v_cvt_pk_bf16_f32 v60, v144, v145
    v_cvt_pk_bf16_f32 v61, v146, v147
    ds_write_b64 v4, v[60:61] offset:576
    v_lshlrev_b32 v20, 16, v74
    v_and_b32 v21, s45, v74
    v_mul_f32 v20, s44, v20
    v_mul_f32 v21, s44, v21
    v_lshlrev_b32 v22, 16, v66
    v_and_b32 v23, s45, v66
    v_mul_f32 v22, v22, v20
    v_mul_f32 v23, v23, v21
    v_cvt_pk_bf16_f32 v42, v22, v23
    v_lshlrev_b32 v22, 16, v70
    v_and_b32 v23, s45, v70
    v_mul_f32 v22, v22, v20
    v_mul_f32 v23, v23, v21
    v_cvt_pk_bf16_f32 v46, v22, v23
    v_lshlrev_b32 v20, 16, v75
    v_and_b32 v21, s45, v75
    v_mul_f32 v20, s44, v20
    v_mul_f32 v21, s44, v21
    v_lshlrev_b32 v22, 16, v67
    v_and_b32 v23, s45, v67
    v_mul_f32 v22, v22, v20
    v_mul_f32 v23, v23, v21
    v_cvt_pk_bf16_f32 v43, v22, v23
    v_lshlrev_b32 v22, 16, v71
    v_and_b32 v23, s45, v71
    v_mul_f32 v22, v22, v20
    v_mul_f32 v23, v23, v21
    v_cvt_pk_bf16_f32 v47, v22, v23
    s_waitcnt vmcnt(2)
    s_xor_b32 s42, s40, 0x2000
    buffer_load_dwordx4 v[128:131], v2, s[8:11], s42 offen nt
    v_cvt_f32_i32 v148, v148
    v_cvt_f32_i32 v149, v149
    v_cvt_f32_i32 v150, v150
    v_cvt_f32_i32 v151, v151
    v_cvt_pk_bf16_f32 v62, v148, v149
    v_cvt_pk_bf16_f32 v63, v150, v151
    ds_write_b64 v4, v[62:63] offset:5184
    v_dot2_f32_bf16 v24, v40, v76, 0
    v_dot2_f32_bf16 v25, v44, v76, 0
    v_dot2_f32_bf16 v24, v41, v77, v24
    v_dot2_f32_bf16 v25, v45, v77, v25
    v_dot2_f32_bf16 v24, v42, v78, v24
    v_dot2_f32_bf16 v25, v46, v78, v25
    v_dot2_f32_bf16 v24, v43, v79, v24
    v_dot2_f32_bf16 v25, v47, v79, v25
    ds_write_b128 v15, v[40:43]
    ds_write_b128 v15, v[44:47] offset:1408
    s_nop 0
    v_add_f32_dpp v24, v24, v24 row_ror:8 row_mask:0xf bank_mask:0xf
    v_add_f32_dpp v25, v25, v25 row_ror:8 row_mask:0xf bank_mask:0xf
    s_nop 0
    v_add_f32_dpp v24, v24, v24 row_ror:4 row_mask:0xf bank_mask:0xf
    v_add_f32_dpp v25, v25, v25 row_ror:4 row_mask:0xf bank_mask:0xf
    s_nop 0
    v_add_f32_dpp v24, v24, v24 row_ror:2 row_mask:0xf bank_mask:0xf
    v_add_f32_dpp v25, v25, v25 row_ror:2 row_mask:0xf bank_mask:0xf
    s_nop 0
    v_add_f32_dpp v24, v24, v24 row_ror:1 row_mask:0xf bank_mask:0xf
    v_add_f32_dpp v25, v25, v25 row_ror:1 row_mask:0xf bank_mask:0xf
    s_mov_b32 exec_lo, 0x000f000f
    s_mov_b32 exec_hi, 0x000f000f
    ds_write_b32 v15, v24 offset:256
    ds_write_b32 v15, v25 offset:1664
    s_mov_b64 exec, -1
    s_waitcnt vmcnt(2)
    s_xor_b32 s42, s40, 0x2400
    buffer_load_dwordx4 v[132:135], v2, s[8:11], s42 offen nt
    v_cvt_f32_i32 v152, v152
    v_cvt_f32_i32 v153, v153
    v_cvt_f32_i32 v154, v154
    v_cvt_f32_i32 v155, v155
    v_cvt_pk_bf16_f32 v60, v152, v153
    v_cvt_pk_bf16_f32 v61, v154, v155
    ds_write_b64 v4, v[60:61] offset:2880
    s_waitcnt lgkmcnt(0)
    s_barrier
    s_waitcnt vmcnt(2)
    s_xor_b32 s42, s40, 0x2200
    buffer_load_dwordx4 v[136:139], v2, s[8:11], s42 offen nt
    v_cvt_f32_i32 v156, v156
    v_cvt_f32_i32 v157, v157
    v_cvt_f32_i32 v158, v158
    v_cvt_f32_i32 v159, v159
    v_cvt_pk_bf16_f32 v62, v156, v157
    v_cvt_pk_bf16_f32 v63, v158, v159
    ds_write_b64 v4, v[62:63] offset:7488
    s_waitcnt vmcnt(2)
    s_xor_b32 s42, s40, 0x2600
    buffer_load_dwordx4 v[140:143], v2, s[8:11], s42 offen nt
    v_cvt_f32_i32 v128, v128
    v_cvt_f32_i32 v129, v129
    v_cvt_f32_i32 v130, v130
    v_cvt_f32_i32 v131, v131
    v_cvt_pk_bf16_f32 v60, v128, v129
    v_cvt_pk_bf16_f32 v61, v130, v131
    ds_write_b64 v4, v[60:61] offset:1152
    s_waitcnt vmcnt(2)
    s_xor_b32 s42, s40, 0x2800
    buffer_load_dwordx4 v[144:147], v2, s[8:11], s42 offen nt
    v_cvt_f32_i32 v132, v132
    v_cvt_f32_i32 v133, v133
    v_cvt_f32_i32 v134, v134
    v_cvt_f32_i32 v135, v135
    v_cvt_pk_bf16_f32 v62, v132, v133
    v_cvt_pk_bf16_f32 v63, v134, v135
    ds_write_b64 v4, v[62:63] offset:5760
    s_waitcnt vmcnt(2)
    s_xor_b32 s42, s40, 0x2c00
    buffer_load_dwordx4 v[148:151], v2, s[8:11], s42 offen nt
    v_cvt_f32_i32 v136, v136
    v_cvt_f32_i32 v137, v137
    v_cvt_f32_i32 v138, v138
    v_cvt_f32_i32 v139, v139
    v_cvt_pk_bf16_f32 v60, v136, v137
    v_cvt_pk_bf16_f32 v61, v138, v139
    ds_write_b64 v4, v[60:61] offset:3456
    s_waitcnt vmcnt(2)
    s_xor_b32 s42, s40, 0x2a00
    buffer_load_dwordx4 v[152:155], v2, s[8:11], s42 offen nt
    v_cvt_f32_i32 v140, v140
    v_cvt_f32_i32 v141, v141
    v_cvt_f32_i32 v142, v142
    v_cvt_f32_i32 v143, v143
    v_cvt_pk_bf16_f32 v62, v140, v141
    v_cvt_pk_bf16_f32 v63, v142, v143
    ds_write_b64 v4, v[62:63] offset:8064
    s_waitcnt vmcnt(2)
    s_xor_b32 s42, s40, 0x2e00
    buffer_load_dwordx4 v[156:159], v2, s[8:11], s42 offen nt
    v_cvt_f32_i32 v144, v144
    v_cvt_f32_i32 v145, v145
    v_cvt_f32_i32 v146, v146
    v_cvt_f32_i32 v147, v147
    v_cvt_pk_bf16_f32 v60, v144, v145
    v_cvt_pk_bf16_f32 v61, v146, v147
    ds_write_b64 v4, v[60:61] offset:1728
    s_waitcnt vmcnt(2)
    s_xor_b32 s42, s40, 0x400000
    buffer_load_dwordx4 v[128:131], v2, s[8:11], s42 offen nt
    v_cvt_f32_i32 v148, v148
    v_cvt_f32_i32 v149, v149
    v_cvt_f32_i32 v150, v150
    v_cvt_f32_i32 v151, v151
    v_cvt_pk_bf16_f32 v62, v148, v149
    v_cvt_pk_bf16_f32 v63, v150, v151
    ds_write_b64 v4, v[62:63] offset:6336
    ds_read_b128 v[40:43], v6 offset:0
    ds_read_b128 v[44:47], v6 offset:64
    ds_read_b128 v[48:51], v6 offset:128
    ds_read_b128 v[52:55], v6 offset:192
    ds_read_b32 v56, v6 offset:256
    s_waitcnt vmcnt(2)
    s_xor_b32 s42, s40, 0x400400
    buffer_load_dwordx4 v[132:135], v2, s[8:11], s42 offen nt
    v_cvt_f32_i32 v152, v152
    v_cvt_f32_i32 v153, v153
    v_cvt_f32_i32 v154, v154
    v_cvt_f32_i32 v155, v155
    v_cvt_pk_bf16_f32 v60, v152, v153
    v_cvt_pk_bf16_f32 v61, v154, v155
    ds_write_b64 v4, v[60:61] offset:4032
    s_waitcnt vmcnt(2)
    s_xor_b32 s42, s40, 0x400200
    buffer_load_dwordx4 v[136:139], v2, s[8:11], s42 offen nt
    v_cvt_f32_i32 v156, v156
    v_cvt_f32_i32 v157, v157
    v_cvt_f32_i32 v158, v158
    v_cvt_f32_i32 v159, v159
    v_cvt_pk_bf16_f32 v62, v156, v157
    v_cvt_pk_bf16_f32 v63, v158, v159
    ds_write_b64 v4, v[62:63] offset:8640
    ds_read_b128 v[64:67], v5 offset:0
    ds_read_b128 v[80:83], v5 offset:4608
    ds_read_b128 v[68:71], v5 offset:64
    ds_read_b128 v[84:87], v5 offset:4672
    ds_read_b128 v[72:75], v5 offset:128
    ds_read_b128 v[88:91], v5 offset:4736
    ds_read_b128 v[76:79], v5 offset:192
    ds_read_b128 v[92:95], v5 offset:4800
    s_waitcnt vmcnt(2)
    s_xor_b32 s42, s40, 0x400600
    buffer_load_dwordx4 v[140:143], v2, s[8:11], s42 offen nt
    s_waitcnt lgkmcnt(7)
    v_mfma_f32_16x16x32_bf16 v[16:19], v[64:67], v[40:43], 0
    s_waitcnt lgkmcnt(6)
    v_mfma_f32_16x16x32_bf16 v[20:23], v[80:83], v[40:43], 0
    s_waitcnt lgkmcnt(5)
    v_mfma_f32_16x16x32_bf16 v[16:19], v[68:71], v[44:47], v[16:19]
    s_waitcnt lgkmcnt(4)
    v_mfma_f32_16x16x32_bf16 v[20:23], v[84:87], v[44:47], v[20:23]
    v_cvt_f32_i32 v128, v128
    v_cvt_f32_i32 v129, v129
    v_cvt_f32_i32 v130, v130
    v_cvt_f32_i32 v131, v131
    v_cvt_pk_bf16_f32 v60, v128, v129
    v_cvt_pk_bf16_f32 v61, v130, v131
    ds_write_b64 v4, v[60:61] offset:0
    s_waitcnt vmcnt(2)
    s_xor_b32 s42, s40, 0x400800
    buffer_load_dwordx4 v[144:147], v2, s[8:11], s42 offen nt
    s_waitcnt lgkmcnt(4)
    v_mfma_f32_16x16x32_bf16 v[16:19], v[72:75], v[48:51], v[16:19]
    s_waitcnt lgkmcnt(3)
    v_mfma_f32_16x16x32_bf16 v[20:23], v[88:91], v[48:51], v[20:23]
    s_waitcnt lgkmcnt(2)
    v_mfma_f32_16x16x32_bf16 v[16:19], v[76:79], v[52:55], v[16:19]
    s_waitcnt lgkmcnt(1)
    v_mfma_f32_16x16x32_bf16 v[20:23], v[92:95], v[52:55], v[20:23]
    v_cvt_f32_i32 v132, v132
    v_cvt_f32_i32 v133, v133
    v_cvt_f32_i32 v134, v134
    v_cvt_f32_i32 v135, v135
    v_cvt_pk_bf16_f32 v62, v132, v133
    v_cvt_pk_bf16_f32 v63, v134, v135
    ds_write_b64 v4, v[62:63] offset:4608
    s_waitcnt vmcnt(2)
    s_xor_b32 s42, s40, 0x400c00
    buffer_load_dwordx4 v[148:151], v2, s[8:11], s42 offen nt
    v_cvt_f32_i32 v136, v136
    v_cvt_f32_i32 v137, v137
    v_cvt_f32_i32 v138, v138
    v_cvt_f32_i32 v139, v139
    v_cvt_pk_bf16_f32 v60, v136, v137
    v_cvt_pk_bf16_f32 v61, v138, v139
    ds_write_b64 v4, v[60:61] offset:2304
    s_waitcnt vmcnt(2)
    s_xor_b32 s42, s40, 0x400a00
    buffer_load_dwordx4 v[152:155], v2, s[8:11], s42 offen nt
    v_cvt_f32_i32 v140, v140
    v_cvt_f32_i32 v141, v141
    v_cvt_f32_i32 v142, v142
    v_cvt_f32_i32 v143, v143
    v_cvt_pk_bf16_f32 v62, v140, v141
    v_cvt_pk_bf16_f32 v63, v142, v143
    ds_write_b64 v4, v[62:63] offset:6912
    v_sub_f32 v96, v16, v56
    v_sub_f32 v97, v17, v56
    v_sub_f32 v98, v18, v56
    v_sub_f32 v99, v19, v56
    v_sub_f32 v100, v20, v56
    v_sub_f32 v101, v21, v56
    v_sub_f32 v102, v22, v56
    v_sub_f32 v103, v23, v56
    s_waitcnt vmcnt(2)
    s_xor_b32 s42, s40, 0x400e00
    buffer_load_dwordx4 v[156:159], v2, s[8:11], s42 offen nt
    v_cvt_f32_i32 v144, v144
    v_cvt_f32_i32 v145, v145
    v_cvt_f32_i32 v146, v146
    v_cvt_f32_i32 v147, v147
    v_cvt_pk_bf16_f32 v60, v144, v145
    v_cvt_pk_bf16_f32 v61, v146, v147
    ds_write_b64 v4, v[60:61] offset:576
    v_max3_f32 v8, v8, v96, v97
    v_max3_f32 v8, v8, v98, v99
    v_max3_f32 v8, v8, v100, v101
    v_max3_f32 v8, v8, v102, v103
    s_waitcnt vmcnt(2)
    s_xor_b32 s42, s40, 0x402000
    buffer_load_dwordx4 v[128:131], v2, s[8:11], s42 offen nt
    v_cvt_f32_i32 v148, v148
    v_cvt_f32_i32 v149, v149
    v_cvt_f32_i32 v150, v150
    v_cvt_f32_i32 v151, v151
    v_cvt_pk_bf16_f32 v62, v148, v149
    v_cvt_pk_bf16_f32 v63, v150, v151
    ds_write_b64 v4, v[62:63] offset:5184
    s_waitcnt vmcnt(2)
    s_xor_b32 s42, s40, 0x402400
    buffer_load_dwordx4 v[132:135], v2, s[8:11], s42 offen nt
    global_load_dword v13, v12, s[26:27] nt
    v_cvt_f32_i32 v152, v152
    v_cvt_f32_i32 v153, v153
    v_cvt_f32_i32 v154, v154
    v_cvt_f32_i32 v155, v155
    v_cvt_pk_bf16_f32 v60, v152, v153
    v_cvt_pk_bf16_f32 v61, v154, v155
    ds_write_b64 v4, v[60:61] offset:2880
    s_waitcnt vmcnt(3)
    s_xor_b32 s42, s40, 0x402200
    buffer_load_dwordx4 v[136:139], v2, s[8:11], s42 offen nt
    global_load_dword v14, v12, s[28:29] nt
    v_cvt_f32_i32 v156, v156
    v_cvt_f32_i32 v157, v157
    v_cvt_f32_i32 v158, v158
    v_cvt_f32_i32 v159, v159
    v_cvt_pk_bf16_f32 v62, v156, v157
    v_cvt_pk_bf16_f32 v63, v158, v159
    ds_write_b64 v4, v[62:63] offset:7488
    s_waitcnt vmcnt(4)
    s_xor_b32 s42, s40, 0x402600
    buffer_load_dwordx4 v[140:143], v2, s[8:11], s42 offen nt
    v_cvt_f32_i32 v128, v128
    v_cvt_f32_i32 v129, v129
    v_cvt_f32_i32 v130, v130
    v_cvt_f32_i32 v131, v131
    v_cvt_pk_bf16_f32 v60, v128, v129
    v_cvt_pk_bf16_f32 v61, v130, v131
    ds_write_b64 v4, v[60:61] offset:1152
    s_waitcnt vmcnt(4)
    s_xor_b32 s42, s40, 0x402800
    buffer_load_dwordx4 v[144:147], v2, s[8:11], s42 offen nt
    v_cvt_f32_i32 v132, v132
    v_cvt_f32_i32 v133, v133
    v_cvt_f32_i32 v134, v134
    v_cvt_f32_i32 v135, v135
    v_cvt_pk_bf16_f32 v62, v132, v133
    v_cvt_pk_bf16_f32 v63, v134, v135
    ds_write_b64 v4, v[62:63] offset:5760
    s_waitcnt vmcnt(3)
    s_xor_b32 s42, s40, 0x402c00
    buffer_load_dwordx4 v[148:151], v2, s[8:11], s42 offen nt
    v_cvt_f32_i32 v136, v136
    v_cvt_f32_i32 v137, v137
    v_cvt_f32_i32 v138, v138
    v_cvt_f32_i32 v139, v139
    v_cvt_pk_bf16_f32 v60, v136, v137
    v_cvt_pk_bf16_f32 v61, v138, v139
    ds_write_b64 v4, v[60:61] offset:3456
    s_waitcnt vmcnt(2)
    s_xor_b32 s42, s40, 0x402a00
    buffer_load_dwordx4 v[152:155], v2, s[8:11], s42 offen nt
    v_cvt_f32_i32 v140, v140
    v_cvt_f32_i32 v141, v141
    v_cvt_f32_i32 v142, v142
    v_cvt_f32_i32 v143, v143
    v_cvt_pk_bf16_f32 v62, v140, v141
    v_cvt_pk_bf16_f32 v63, v142, v143
    ds_write_b64 v4, v[62:63] offset:8064
    s_waitcnt vmcnt(2)
    s_xor_b32 s42, s40, 0x402e00
    buffer_load_dwordx4 v[156:159], v2, s[8:11], s42 offen nt
    v_cvt_f32_i32 v144, v144
    v_cvt_f32_i32 v145, v145
    v_cvt_f32_i32 v146, v146
    v_cvt_f32_i32 v147, v147
    v_cvt_pk_bf16_f32 v60, v144, v145
    v_cvt_pk_bf16_f32 v61, v146, v147
    ds_write_b64 v4, v[60:61] offset:1728
    v_lshlrev_b32 v10, 16, v13
    v_and_b32 v11, s45, v13
    ds_write_b32 v28, v10
    ds_write_b32 v29, v11
    ds_write_b16 v30, v14 offset:32
    ds_write_b16_d16_hi v31, v14 offset:32
    s_waitcnt vmcnt(2)
    s_xor_b32 s42, s40, 0x800000
    buffer_load_dwordx4 v[128:131], v2, s[8:11], s42 offen nt
    v_cvt_f32_i32 v148, v148
    v_cvt_f32_i32 v149, v149
    v_cvt_f32_i32 v150, v150
    v_cvt_f32_i32 v151, v151
    v_cvt_pk_bf16_f32 v62, v148, v149
    v_cvt_pk_bf16_f32 v63, v150, v151
    ds_write_b64 v4, v[62:63] offset:6336
    ds_read_b128 v[40:43], v6 offset:5632
    ds_read_b128 v[44:47], v6 offset:5696
    ds_read_b128 v[48:51], v6 offset:5760
    ds_read_b128 v[52:55], v6 offset:5824
    ds_read_b32 v56, v6 offset:5888
    s_waitcnt vmcnt(2)
    s_xor_b32 s42, s40, 0x800400
    buffer_load_dwordx4 v[132:135], v2, s[8:11], s42 offen nt
    v_cvt_f32_i32 v152, v152
    v_cvt_f32_i32 v153, v153
    v_cvt_f32_i32 v154, v154
    v_cvt_f32_i32 v155, v155
    v_cvt_pk_bf16_f32 v60, v152, v153
    v_cvt_pk_bf16_f32 v61, v154, v155
    ds_write_b64 v4, v[60:61] offset:4032
    s_waitcnt vmcnt(2)
    s_xor_b32 s42, s40, 0x800200
    buffer_load_dwordx4 v[136:139], v2, s[8:11], s42 offen nt
    v_cvt_f32_i32 v156, v156
    v_cvt_f32_i32 v157, v157
    v_cvt_f32_i32 v158, v158
    v_cvt_f32_i32 v159, v159
    v_cvt_pk_bf16_f32 v62, v156, v157
    v_cvt_pk_bf16_f32 v63, v158, v159
    ds_write_b64 v4, v[62:63] offset:8640
    ds_read_b128 v[64:67], v5 offset:0
    ds_read_b128 v[80:83], v5 offset:4608
    ds_read_b128 v[68:71], v5 offset:64
    ds_read_b128 v[84:87], v5 offset:4672
    ds_read_b128 v[72:75], v5 offset:128
    ds_read_b128 v[88:91], v5 offset:4736
    ds_read_b128 v[76:79], v5 offset:192
    ds_read_b128 v[92:95], v5 offset:4800
    s_waitcnt vmcnt(2)
    s_xor_b32 s42, s40, 0x800600
    buffer_load_dwordx4 v[140:143], v2, s[8:11], s42 offen nt
    s_waitcnt lgkmcnt(7)
    v_mfma_f32_16x16x32_bf16 v[16:19], v[64:67], v[40:43], 0
    s_waitcnt lgkmcnt(6)
    v_mfma_f32_16x16x32_bf16 v[20:23], v[80:83], v[40:43], 0
    s_waitcnt lgkmcnt(5)
    v_mfma_f32_16x16x32_bf16 v[16:19], v[68:71], v[44:47], v[16:19]
    s_waitcnt lgkmcnt(4)
    v_mfma_f32_16x16x32_bf16 v[20:23], v[84:87], v[44:47], v[20:23]
    v_cvt_f32_i32 v128, v128
    v_cvt_f32_i32 v129, v129
    v_cvt_f32_i32 v130, v130
    v_cvt_f32_i32 v131, v131
    v_cvt_pk_bf16_f32 v60, v128, v129
    v_cvt_pk_bf16_f32 v61, v130, v131
    ds_write_b64 v4, v[60:61] offset:0
    s_waitcnt vmcnt(2)
    s_xor_b32 s42, s40, 0x800800
    buffer_load_dwordx4 v[144:147], v2, s[8:11], s42 offen nt
    s_waitcnt lgkmcnt(4)
    v_mfma_f32_16x16x32_bf16 v[16:19], v[72:75], v[48:51], v[16:19]
    s_waitcnt lgkmcnt(3)
    v_mfma_f32_16x16x32_bf16 v[20:23], v[88:91], v[48:51], v[20:23]
    s_waitcnt lgkmcnt(2)
    v_mfma_f32_16x16x32_bf16 v[16:19], v[76:79], v[52:55], v[16:19]
    s_waitcnt lgkmcnt(1)
    v_mfma_f32_16x16x32_bf16 v[20:23], v[92:95], v[52:55], v[20:23]
    v_cvt_f32_i32 v132, v132
    v_cvt_f32_i32 v133, v133
    v_cvt_f32_i32 v134, v134
    v_cvt_f32_i32 v135, v135
    v_cvt_pk_bf16_f32 v62, v132, v133
    v_cvt_pk_bf16_f32 v63, v134, v135
    ds_write_b64 v4, v[62:63] offset:4608
    s_waitcnt vmcnt(2)
    s_xor_b32 s42, s40, 0x800c00
    buffer_load_dwordx4 v[148:151], v2, s[8:11], s42 offen nt
    v_cvt_f32_i32 v136, v136
    v_cvt_f32_i32 v137, v137
    v_cvt_f32_i32 v138, v138
    v_cvt_f32_i32 v139, v139
    v_cvt_pk_bf16_f32 v60, v136, v137
    v_cvt_pk_bf16_f32 v61, v138, v139
    ds_write_b64 v4, v[60:61] offset:2304
    s_waitcnt vmcnt(2)
    s_xor_b32 s42, s40, 0x800a00
    buffer_load_dwordx4 v[152:155], v2, s[8:11], s42 offen nt
    v_cvt_f32_i32 v140, v140
    v_cvt_f32_i32 v141, v141
    v_cvt_f32_i32 v142, v142
    v_cvt_f32_i32 v143, v143
    v_cvt_pk_bf16_f32 v62, v140, v141
    v_cvt_pk_bf16_f32 v63, v142, v143
    ds_write_b64 v4, v[62:63] offset:6912
    v_sub_f32 v104, v16, v56
    v_sub_f32 v105, v17, v56
    v_sub_f32 v106, v18, v56
    v_sub_f32 v107, v19, v56
    v_sub_f32 v108, v20, v56
    v_sub_f32 v109, v21, v56
    v_sub_f32 v110, v22, v56
    v_sub_f32 v111, v23, v56
    s_waitcnt vmcnt(2)
    s_xor_b32 s42, s40, 0x800e00
    buffer_load_dwordx4 v[156:159], v2, s[8:11], s42 offen nt
    v_cvt_f32_i32 v144, v144
    v_cvt_f32_i32 v145, v145
    v_cvt_f32_i32 v146, v146
    v_cvt_f32_i32 v147, v147
    v_cvt_pk_bf16_f32 v60, v144, v145
    v_cvt_pk_bf16_f32 v61, v146, v147
    ds_write_b64 v4, v[60:61] offset:576
    v_max3_f32 v8, v8, v104, v105
    v_max3_f32 v8, v8, v106, v107
    v_max3_f32 v8, v8, v108, v109
    v_max3_f32 v8, v8, v110, v111
    s_waitcnt vmcnt(2)
    s_xor_b32 s42, s40, 0x802000
    buffer_load_dwordx4 v[128:131], v2, s[8:11], s42 offen nt
    v_cvt_f32_i32 v148, v148
    v_cvt_f32_i32 v149, v149
    v_cvt_f32_i32 v150, v150
    v_cvt_f32_i32 v151, v151
    v_cvt_pk_bf16_f32 v62, v148, v149
    v_cvt_pk_bf16_f32 v63, v150, v151
    ds_write_b64 v4, v[62:63] offset:5184
    s_waitcnt vmcnt(2)
    s_xor_b32 s42, s40, 0x802400
    buffer_load_dwordx4 v[132:135], v2, s[8:11], s42 offen nt
    v_cvt_f32_i32 v152, v152
    v_cvt_f32_i32 v153, v153
    v_cvt_f32_i32 v154, v154
    v_cvt_f32_i32 v155, v155
    v_cvt_pk_bf16_f32 v60, v152, v153
    v_cvt_pk_bf16_f32 v61, v154, v155
    ds_write_b64 v4, v[60:61] offset:2880
    s_waitcnt vmcnt(2)
    s_xor_b32 s42, s40, 0x802200
    buffer_load_dwordx4 v[136:139], v2, s[8:11], s42 offen nt
    v_cvt_f32_i32 v156, v156
    v_cvt_f32_i32 v157, v157
    v_cvt_f32_i32 v158, v158
    v_cvt_f32_i32 v159, v159
    v_cvt_pk_bf16_f32 v62, v156, v157
    v_cvt_pk_bf16_f32 v63, v158, v159
    ds_write_b64 v4, v[62:63] offset:7488
    s_waitcnt vmcnt(2)
    s_xor_b32 s42, s40, 0x802600
    buffer_load_dwordx4 v[140:143], v2, s[8:11], s42 offen nt
    v_cvt_f32_i32 v128, v128
    v_cvt_f32_i32 v129, v129
    v_cvt_f32_i32 v130, v130
    v_cvt_f32_i32 v131, v131
    v_cvt_pk_bf16_f32 v60, v128, v129
    v_cvt_pk_bf16_f32 v61, v130, v131
    ds_write_b64 v4, v[60:61] offset:1152
    s_waitcnt vmcnt(2)
    s_xor_b32 s42, s40, 0x802800
    buffer_load_dwordx4 v[144:147], v2, s[8:11], s42 offen nt
    v_cvt_f32_i32 v132, v132
    v_cvt_f32_i32 v133, v133
    v_cvt_f32_i32 v134, v134
    v_cvt_f32_i32 v135, v135
    v_cvt_pk_bf16_f32 v62, v132, v133
    v_cvt_pk_bf16_f32 v63, v134, v135
    ds_write_b64 v4, v[62:63] offset:5760
    s_waitcnt vmcnt(2)
    s_xor_b32 s42, s40, 0x802c00
    buffer_load_dwordx4 v[148:151], v2, s[8:11], s42 offen nt
    v_cvt_f32_i32 v136, v136
    v_cvt_f32_i32 v137, v137
    v_cvt_f32_i32 v138, v138
    v_cvt_f32_i32 v139, v139
    v_cvt_pk_bf16_f32 v60, v136, v137
    v_cvt_pk_bf16_f32 v61, v138, v139
    ds_write_b64 v4, v[60:61] offset:3456
    s_waitcnt vmcnt(2)
    s_xor_b32 s42, s40, 0x802a00
    buffer_load_dwordx4 v[152:155], v2, s[8:11], s42 offen nt
    v_cvt_f32_i32 v140, v140
    v_cvt_f32_i32 v141, v141
    v_cvt_f32_i32 v142, v142
    v_cvt_f32_i32 v143, v143
    v_cvt_pk_bf16_f32 v62, v140, v141
    v_cvt_pk_bf16_f32 v63, v142, v143
    ds_write_b64 v4, v[62:63] offset:8064
    s_waitcnt vmcnt(2)
    s_xor_b32 s42, s40, 0x802e00
    buffer_load_dwordx4 v[156:159], v2, s[8:11], s42 offen nt
    v_cvt_f32_i32 v144, v144
    v_cvt_f32_i32 v145, v145
    v_cvt_f32_i32 v146, v146
    v_cvt_f32_i32 v147, v147
    v_cvt_pk_bf16_f32 v60, v144, v145
    v_cvt_pk_bf16_f32 v61, v146, v147
    ds_write_b64 v4, v[60:61] offset:1728
    s_waitcnt vmcnt(2)
    s_xor_b32 s42, s40, 0xc00000
    buffer_load_dwordx4 v[128:131], v2, s[8:11], s42 offen nt
    v_cvt_f32_i32 v148, v148
    v_cvt_f32_i32 v149, v149
    v_cvt_f32_i32 v150, v150
    v_cvt_f32_i32 v151, v151
    v_cvt_pk_bf16_f32 v62, v148, v149
    v_cvt_pk_bf16_f32 v63, v150, v151
    ds_write_b64 v4, v[62:63] offset:6336
    ds_read_b128 v[40:43], v6 offset:11264
    ds_read_b128 v[44:47], v6 offset:11328
    ds_read_b128 v[48:51], v6 offset:11392
    ds_read_b128 v[52:55], v6 offset:11456
    ds_read_b32 v56, v6 offset:11520
    s_waitcnt vmcnt(2)
    s_xor_b32 s42, s40, 0xc00400
    buffer_load_dwordx4 v[132:135], v2, s[8:11], s42 offen nt
    v_cvt_f32_i32 v152, v152
    v_cvt_f32_i32 v153, v153
    v_cvt_f32_i32 v154, v154
    v_cvt_f32_i32 v155, v155
    v_cvt_pk_bf16_f32 v60, v152, v153
    v_cvt_pk_bf16_f32 v61, v154, v155
    ds_write_b64 v4, v[60:61] offset:4032
    s_waitcnt vmcnt(2)
    s_xor_b32 s42, s40, 0xc00200
    buffer_load_dwordx4 v[136:139], v2, s[8:11], s42 offen nt
    v_cvt_f32_i32 v156, v156
    v_cvt_f32_i32 v157, v157
    v_cvt_f32_i32 v158, v158
    v_cvt_f32_i32 v159, v159
    v_cvt_pk_bf16_f32 v62, v156, v157
    v_cvt_pk_bf16_f32 v63, v158, v159
    ds_write_b64 v4, v[62:63] offset:8640
    ds_read_b128 v[64:67], v5 offset:0
    ds_read_b128 v[80:83], v5 offset:4608
    ds_read_b128 v[68:71], v5 offset:64
    ds_read_b128 v[84:87], v5 offset:4672
    ds_read_b128 v[72:75], v5 offset:128
    ds_read_b128 v[88:91], v5 offset:4736
    ds_read_b128 v[76:79], v5 offset:192
    ds_read_b128 v[92:95], v5 offset:4800
    s_waitcnt vmcnt(2)
    s_xor_b32 s42, s40, 0xc00600
    buffer_load_dwordx4 v[140:143], v2, s[8:11], s42 offen nt
    s_waitcnt lgkmcnt(7)
    v_mfma_f32_16x16x32_bf16 v[16:19], v[64:67], v[40:43], 0
    s_waitcnt lgkmcnt(6)
    v_mfma_f32_16x16x32_bf16 v[20:23], v[80:83], v[40:43], 0
    s_waitcnt lgkmcnt(5)
    v_mfma_f32_16x16x32_bf16 v[16:19], v[68:71], v[44:47], v[16:19]
    s_waitcnt lgkmcnt(4)
    v_mfma_f32_16x16x32_bf16 v[20:23], v[84:87], v[44:47], v[20:23]
    v_cvt_f32_i32 v128, v128
    v_cvt_f32_i32 v129, v129
    v_cvt_f32_i32 v130, v130
    v_cvt_f32_i32 v131, v131
    v_cvt_pk_bf16_f32 v60, v128, v129
    v_cvt_pk_bf16_f32 v61, v130, v131
    ds_write_b64 v4, v[60:61] offset:0
    s_waitcnt vmcnt(2)
    s_xor_b32 s42, s40, 0xc00800
    buffer_load_dwordx4 v[144:147], v2, s[8:11], s42 offen nt
    s_waitcnt lgkmcnt(4)
    v_mfma_f32_16x16x32_bf16 v[16:19], v[72:75], v[48:51], v[16:19]
    s_waitcnt lgkmcnt(3)
    v_mfma_f32_16x16x32_bf16 v[20:23], v[88:91], v[48:51], v[20:23]
    s_waitcnt lgkmcnt(2)
    v_mfma_f32_16x16x32_bf16 v[16:19], v[76:79], v[52:55], v[16:19]
    s_waitcnt lgkmcnt(1)
    v_mfma_f32_16x16x32_bf16 v[20:23], v[92:95], v[52:55], v[20:23]
    v_cvt_f32_i32 v132, v132
    v_cvt_f32_i32 v133, v133
    v_cvt_f32_i32 v134, v134
    v_cvt_f32_i32 v135, v135
    v_cvt_pk_bf16_f32 v62, v132, v133
    v_cvt_pk_bf16_f32 v63, v134, v135
    ds_write_b64 v4, v[62:63] offset:4608
    s_waitcnt vmcnt(2)
    s_xor_b32 s42, s40, 0xc00c00
    buffer_load_dwordx4 v[148:151], v2, s[8:11], s42 offen nt
    v_cvt_f32_i32 v136, v136
    v_cvt_f32_i32 v137, v137
    v_cvt_f32_i32 v138, v138
    v_cvt_f32_i32 v139, v139
    v_cvt_pk_bf16_f32 v60, v136, v137
    v_cvt_pk_bf16_f32 v61, v138, v139
    ds_write_b64 v4, v[60:61] offset:2304
    s_waitcnt vmcnt(2)
    s_xor_b32 s42, s40, 0xc00a00
    buffer_load_dwordx4 v[152:155], v2, s[8:11], s42 offen nt
    v_cvt_f32_i32 v140, v140
    v_cvt_f32_i32 v141, v141
    v_cvt_f32_i32 v142, v142
    v_cvt_f32_i32 v143, v143
    v_cvt_pk_bf16_f32 v62, v140, v141
    v_cvt_pk_bf16_f32 v63, v142, v143
    ds_write_b64 v4, v[62:63] offset:6912
    v_sub_f32 v112, v16, v56
    v_sub_f32 v113, v17, v56
    v_sub_f32 v114, v18, v56
    v_sub_f32 v115, v19, v56
    v_sub_f32 v116, v20, v56
    v_sub_f32 v117, v21, v56
    v_sub_f32 v118, v22, v56
    v_sub_f32 v119, v23, v56
    s_waitcnt vmcnt(2)
    s_xor_b32 s42, s40, 0xc00e00
    buffer_load_dwordx4 v[156:159], v2, s[8:11], s42 offen nt
    v_cvt_f32_i32 v144, v144
    v_cvt_f32_i32 v145, v145
    v_cvt_f32_i32 v146, v146
    v_cvt_f32_i32 v147, v147
    v_cvt_pk_bf16_f32 v60, v144, v145
    v_cvt_pk_bf16_f32 v61, v146, v147
    ds_write_b64 v4, v[60:61] offset:576
    v_max3_f32 v8, v8, v112, v113
    v_max3_f32 v8, v8, v114, v115
    v_max3_f32 v8, v8, v116, v117
    v_max3_f32 v8, v8, v118, v119
    s_waitcnt vmcnt(2)
    s_xor_b32 s42, s40, 0xc02000
    buffer_load_dwordx4 v[128:131], v2, s[8:11], s42 offen nt
    v_cvt_f32_i32 v148, v148
    v_cvt_f32_i32 v149, v149
    v_cvt_f32_i32 v150, v150
    v_cvt_f32_i32 v151, v151
    v_cvt_pk_bf16_f32 v62, v148, v149
    v_cvt_pk_bf16_f32 v63, v150, v151
    ds_write_b64 v4, v[62:63] offset:5184
    s_waitcnt vmcnt(2)
    s_xor_b32 s42, s40, 0xc02400
    buffer_load_dwordx4 v[132:135], v2, s[8:11], s42 offen nt
    v_cvt_f32_i32 v152, v152
    v_cvt_f32_i32 v153, v153
    v_cvt_f32_i32 v154, v154
    v_cvt_f32_i32 v155, v155
    v_cvt_pk_bf16_f32 v60, v152, v153
    v_cvt_pk_bf16_f32 v61, v154, v155
    ds_write_b64 v4, v[60:61] offset:2880
    s_waitcnt vmcnt(2)
    s_xor_b32 s42, s40, 0xc02200
    buffer_load_dwordx4 v[136:139], v2, s[8:11], s42 offen nt
    v_cvt_f32_i32 v156, v156
    v_cvt_f32_i32 v157, v157
    v_cvt_f32_i32 v158, v158
    v_cvt_f32_i32 v159, v159
    v_cvt_pk_bf16_f32 v62, v156, v157
    v_cvt_pk_bf16_f32 v63, v158, v159
    ds_write_b64 v4, v[62:63] offset:7488
    s_waitcnt vmcnt(2)
    s_xor_b32 s42, s40, 0xc02600
    buffer_load_dwordx4 v[140:143], v2, s[8:11], s42 offen nt
    v_cvt_f32_i32 v128, v128
    v_cvt_f32_i32 v129, v129
    v_cvt_f32_i32 v130, v130
    v_cvt_f32_i32 v131, v131
    v_cvt_pk_bf16_f32 v60, v128, v129
    v_cvt_pk_bf16_f32 v61, v130, v131
    ds_write_b64 v4, v[60:61] offset:1152
    s_waitcnt vmcnt(2)
    s_xor_b32 s42, s40, 0xc02800
    buffer_load_dwordx4 v[144:147], v2, s[8:11], s42 offen nt
    v_cvt_f32_i32 v132, v132
    v_cvt_f32_i32 v133, v133
    v_cvt_f32_i32 v134, v134
    v_cvt_f32_i32 v135, v135
    v_cvt_pk_bf16_f32 v62, v132, v133
    v_cvt_pk_bf16_f32 v63, v134, v135
    ds_write_b64 v4, v[62:63] offset:5760
    s_waitcnt vmcnt(2)
    s_xor_b32 s42, s40, 0xc02c00
    buffer_load_dwordx4 v[148:151], v2, s[8:11], s42 offen nt
    v_cvt_f32_i32 v136, v136
    v_cvt_f32_i32 v137, v137
    v_cvt_f32_i32 v138, v138
    v_cvt_f32_i32 v139, v139
    v_cvt_pk_bf16_f32 v60, v136, v137
    v_cvt_pk_bf16_f32 v61, v138, v139
    ds_write_b64 v4, v[60:61] offset:3456
    s_waitcnt vmcnt(2)
    s_xor_b32 s42, s40, 0xc02a00
    buffer_load_dwordx4 v[152:155], v2, s[8:11], s42 offen nt
    v_cvt_f32_i32 v140, v140
    v_cvt_f32_i32 v141, v141
    v_cvt_f32_i32 v142, v142
    v_cvt_f32_i32 v143, v143
    v_cvt_pk_bf16_f32 v62, v140, v141
    v_cvt_pk_bf16_f32 v63, v142, v143
    ds_write_b64 v4, v[62:63] offset:8064
    s_waitcnt vmcnt(2)
    s_xor_b32 s42, s40, 0xc02e00
    buffer_load_dwordx4 v[156:159], v2, s[8:11], s42 offen nt
    v_cvt_f32_i32 v144, v144
    v_cvt_f32_i32 v145, v145
    v_cvt_f32_i32 v146, v146
    v_cvt_f32_i32 v147, v147
    v_cvt_pk_bf16_f32 v60, v144, v145
    v_cvt_pk_bf16_f32 v61, v146, v147
    ds_write_b64 v4, v[60:61] offset:1728
    s_waitcnt vmcnt(2)
    s_xor_b32 s42, s41, 0x0
    buffer_load_dwordx4 v[128:131], v3, s[12:15], s42 offen nt
    v_cvt_f32_i32 v148, v148
    v_cvt_f32_i32 v149, v149
    v_cvt_f32_i32 v150, v150
    v_cvt_f32_i32 v151, v151
    v_cvt_pk_bf16_f32 v62, v148, v149
    v_cvt_pk_bf16_f32 v63, v150, v151
    ds_write_b64 v4, v[62:63] offset:6336
    ds_read_b128 v[40:43], v6 offset:16896
    ds_read_b128 v[44:47], v6 offset:16960
    ds_read_b128 v[48:51], v6 offset:17024
    ds_read_b128 v[52:55], v6 offset:17088
    ds_read_b32 v56, v6 offset:17152
    s_waitcnt vmcnt(2)
    s_xor_b32 s42, s41, 0x1000
    buffer_load_dwordx4 v[132:135], v3, s[12:15], s42 offen nt
    v_cvt_f32_i32 v152, v152
    v_cvt_f32_i32 v153, v153
    v_cvt_f32_i32 v154, v154
    v_cvt_f32_i32 v155, v155
    v_cvt_pk_bf16_f32 v60, v152, v153
    v_cvt_pk_bf16_f32 v61, v154, v155
    ds_write_b64 v4, v[60:61] offset:4032
    s_waitcnt vmcnt(2)
    s_xor_b32 s42, s41, 0x100
    buffer_load_dwordx4 v[136:139], v3, s[12:15], s42 offen nt
    v_cvt_f32_i32 v156, v156
    v_cvt_f32_i32 v157, v157
    v_cvt_f32_i32 v158, v158
    v_cvt_f32_i32 v159, v159
    v_cvt_pk_bf16_f32 v62, v156, v157
    v_cvt_pk_bf16_f32 v63, v158, v159
    ds_write_b64 v4, v[62:63] offset:8640
    ds_read_b128 v[64:67], v5 offset:0
    ds_read_b128 v[80:83], v5 offset:4608
    ds_read_b128 v[68:71], v5 offset:64
    ds_read_b128 v[84:87], v5 offset:4672
    ds_read_b128 v[72:75], v5 offset:128
    ds_read_b128 v[88:91], v5 offset:4736
    ds_read_b128 v[76:79], v5 offset:192
    ds_read_b128 v[92:95], v5 offset:4800
    s_waitcnt vmcnt(2)
    s_xor_b32 s42, s41, 0x1100
    buffer_load_dwordx4 v[140:143], v3, s[12:15], s42 offen nt
    s_waitcnt lgkmcnt(7)
    v_mfma_f32_16x16x32_bf16 v[16:19], v[64:67], v[40:43], 0
    s_waitcnt lgkmcnt(6)
    v_mfma_f32_16x16x32_bf16 v[20:23], v[80:83], v[40:43], 0
    s_waitcnt lgkmcnt(5)
    v_mfma_f32_16x16x32_bf16 v[16:19], v[68:71], v[44:47], v[16:19]
    s_waitcnt lgkmcnt(4)
    v_mfma_f32_16x16x32_bf16 v[20:23], v[84:87], v[44:47], v[20:23]
    v_cvt_f32_i32 v128, v128
    v_cvt_f32_i32 v129, v129
    v_cvt_f32_i32 v130, v130
    v_cvt_f32_i32 v131, v131
    s_waitcnt vmcnt(2)
    s_xor_b32 s42, s41, 0x800
    buffer_load_dwordx4 v[144:147], v3, s[12:15], s42 offen nt
    s_waitcnt lgkmcnt(3)
    v_mfma_f32_16x16x32_bf16 v[16:19], v[72:75], v[48:51], v[16:19]
    s_waitcnt lgkmcnt(2)
    v_mfma_f32_16x16x32_bf16 v[20:23], v[88:91], v[48:51], v[20:23]
    s_waitcnt lgkmcnt(1)
    v_mfma_f32_16x16x32_bf16 v[16:19], v[76:79], v[52:55], v[16:19]
    s_waitcnt lgkmcnt(0)
    v_mfma_f32_16x16x32_bf16 v[20:23], v[92:95], v[52:55], v[20:23]
    v_cvt_f32_i32 v132, v132
    v_cvt_f32_i32 v133, v133
    v_cvt_f32_i32 v134, v134
    v_cvt_f32_i32 v135, v135
    s_nop 3
    v_cvt_pk_bf16_f32 v64, v128, v132
    v_cvt_pk_bf16_f32 v68, v129, v133
    v_cvt_pk_bf16_f32 v72, v130, v134
    v_cvt_pk_bf16_f32 v76, v131, v135
    s_waitcnt vmcnt(2)
    s_xor_b32 s42, s41, 0x1800
    buffer_load_dwordx4 v[148:151], v3, s[12:15], s42 offen nt
    v_cvt_f32_i32 v136, v136
    v_cvt_f32_i32 v137, v137
    v_cvt_f32_i32 v138, v138
    v_cvt_f32_i32 v139, v139
    ds_read_b128 v[28:31], v7 offset:0
    ds_read_b128 v[32:35], v7 offset:16
    ds_read_b128 v[36:39], v7 offset:32
    v_sub_f32 v120, v16, v56
    v_sub_f32 v121, v17, v56
    v_sub_f32 v122, v18, v56
    v_sub_f32 v123, v19, v56
    v_sub_f32 v124, v20, v56
    v_sub_f32 v125, v21, v56
    v_sub_f32 v126, v22, v56
    v_sub_f32 v127, v23, v56
    v_max3_f32 v8, v8, v120, v121
    v_max3_f32 v8, v8, v122, v123
    v_max3_f32 v8, v8, v124, v125
    v_max3_f32 v8, v8, v126, v127
    v_mov_b32 v11, v8
    s_waitcnt vmcnt(2)
    s_xor_b32 s42, s41, 0x900
    buffer_load_dwordx4 v[152:155], v3, s[12:15], s42 offen nt
    v_cvt_f32_i32 v140, v140
    v_cvt_f32_i32 v141, v141
    v_cvt_f32_i32 v142, v142
    v_cvt_f32_i32 v143, v143
    v_permlane32_swap_b32 v8, v11
    v_max_f32 v8, v8, v11
    v_mov_b32 v11, v8
    s_nop 1
    v_permlane16_swap_b32 v8, v11
    v_max_f32 v8, v8, v11
    v_cvt_pk_bf16_f32 v80, v136, v140
    v_cvt_pk_bf16_f32 v84, v137, v141
    v_cvt_pk_bf16_f32 v88, v138, v142
    v_cvt_pk_bf16_f32 v92, v139, v143
    s_waitcnt vmcnt(2)
    s_xor_b32 s42, s41, 0x1900
    buffer_load_dwordx4 v[156:159], v3, s[12:15], s42 offen nt
    v_cvt_f32_i32 v144, v144
    v_cvt_f32_i32 v145, v145
    v_cvt_f32_i32 v146, v146
    v_cvt_f32_i32 v147, v147
    v_sub_f32 v96, v96, v8
    v_sub_f32 v97, v97, v8
    v_sub_f32 v98, v98, v8
    v_sub_f32 v99, v99, v8
    v_sub_f32 v100, v100, v8
    v_sub_f32 v101, v101, v8
    v_sub_f32 v102, v102, v8
    v_sub_f32 v103, v103, v8
    v_exp_f32 v96, v96
    v_exp_f32 v97, v97
    v_exp_f32 v98, v98
    v_exp_f32 v99, v99
    v_exp_f32 v100, v100
    v_exp_f32 v101, v101
    v_exp_f32 v102, v102
    v_exp_f32 v103, v103
    s_waitcnt vmcnt(2)
    s_xor_b32 s42, s41, 0x400
    buffer_load_dwordx4 v[128:131], v3, s[12:15], s42 offen nt
    v_cvt_f32_i32 v148, v148
    v_cvt_f32_i32 v149, v149
    v_cvt_f32_i32 v150, v150
    v_cvt_f32_i32 v151, v151
    v_add_f32 v9, v9, v96
    v_add_f32 v9, v9, v97
    v_add_f32 v9, v9, v98
    v_add_f32 v9, v9, v99
    v_add_f32 v9, v9, v100
    v_add_f32 v9, v9, v101
    v_add_f32 v9, v9, v102
    v_add_f32 v9, v9, v103
    s_waitcnt lgkmcnt(0)
    ds_read_b128 v[16:19], v7 offset:256
    ds_read_b128 v[20:23], v7 offset:272
    ds_read_b128 v[24:27], v7 offset:288
    v_mul_f32 v96, v96, v28
    v_mul_f32 v97, v97, v29
    v_mul_f32 v98, v98, v30
    v_mul_f32 v99, v99, v31
    v_mul_f32 v100, v100, v32
    v_mul_f32 v101, v101, v33
    v_mul_f32 v102, v102, v34
    v_mul_f32 v103, v103, v35
    v_cvt_pk_bf16_f32 v40, v96, v97
    v_cvt_pk_bf16_f32 v41, v98, v99
    v_cvt_pk_bf16_f32 v42, v100, v101
    v_cvt_pk_bf16_f32 v43, v102, v103
    v_cvt_pk_bf16_f32 v65, v144, v148
    v_cvt_pk_bf16_f32 v69, v145, v149
    v_cvt_pk_bf16_f32 v73, v146, v150
    v_cvt_pk_bf16_f32 v77, v147, v151
    s_waitcnt vmcnt(2)
    s_xor_b32 s42, s41, 0x1400
    buffer_load_dwordx4 v[132:135], v3, s[12:15], s42 offen nt
    v_cvt_f32_i32 v152, v152
    v_cvt_f32_i32 v153, v153
    v_cvt_f32_i32 v154, v154
    v_cvt_f32_i32 v155, v155
    v_mfma_f32_16x16x32_bf16 v[12:15], v[36:39], v[40:43], 0
    v_sub_f32 v104, v104, v8
    v_sub_f32 v105, v105, v8
    v_sub_f32 v106, v106, v8
    v_sub_f32 v107, v107, v8
    v_sub_f32 v108, v108, v8
    v_sub_f32 v109, v109, v8
    v_sub_f32 v110, v110, v8
    v_sub_f32 v111, v111, v8
    v_exp_f32 v104, v104
    v_exp_f32 v105, v105
    v_exp_f32 v106, v106
    v_exp_f32 v107, v107
    v_exp_f32 v108, v108
    v_exp_f32 v109, v109
    v_exp_f32 v110, v110
    v_exp_f32 v111, v111
    s_waitcnt vmcnt(2)
    s_xor_b32 s42, s41, 0x500
    buffer_load_dwordx4 v[136:139], v3, s[12:15], s42 offen nt
    v_cvt_f32_i32 v156, v156
    v_cvt_f32_i32 v157, v157
    v_cvt_f32_i32 v158, v158
    v_cvt_f32_i32 v159, v159
    v_add_f32 v9, v9, v104
    v_add_f32 v9, v9, v105
    v_add_f32 v9, v9, v106
    v_add_f32 v9, v9, v107
    v_add_f32 v9, v9, v108
    v_add_f32 v9, v9, v109
    v_add_f32 v9, v9, v110
    v_add_f32 v9, v9, v111
    s_waitcnt lgkmcnt(0)
    ds_read_b128 v[28:31], v7 offset:512
    ds_read_b128 v[32:35], v7 offset:528
    ds_read_b128 v[36:39], v7 offset:544
    v_mul_f32 v104, v104, v16
    v_mul_f32 v105, v105, v17
    v_mul_f32 v106, v106, v18
    v_mul_f32 v107, v107, v19
    v_mul_f32 v108, v108, v20
    v_mul_f32 v109, v109, v21
    v_mul_f32 v110, v110, v22
    v_mul_f32 v111, v111, v23
    v_cvt_pk_bf16_f32 v44, v104, v105
    v_cvt_pk_bf16_f32 v45, v106, v107
    v_cvt_pk_bf16_f32 v46, v108, v109
    v_cvt_pk_bf16_f32 v47, v110, v111
    v_cvt_pk_bf16_f32 v81, v152, v156
    v_cvt_pk_bf16_f32 v85, v153, v157
    v_cvt_pk_bf16_f32 v89, v154, v158
    v_cvt_pk_bf16_f32 v93, v155, v159
    s_waitcnt vmcnt(2)
    s_xor_b32 s42, s41, 0x1500
    buffer_load_dwordx4 v[140:143], v3, s[12:15], s42 offen nt
    v_cvt_f32_i32 v128, v128
    v_cvt_f32_i32 v129, v129
    v_cvt_f32_i32 v130, v130
    v_cvt_f32_i32 v131, v131
    v_mfma_f32_16x16x32_bf16 v[12:15], v[24:27], v[44:47], v[12:15]
    v_sub_f32 v112, v112, v8
    v_sub_f32 v113, v113, v8
    v_sub_f32 v114, v114, v8
    v_sub_f32 v115, v115, v8
    v_sub_f32 v116, v116, v8
    v_sub_f32 v117, v117, v8
    v_sub_f32 v118, v118, v8
    v_sub_f32 v119, v119, v8
    v_exp_f32 v112, v112
    v_exp_f32 v113, v113
    v_exp_f32 v114, v114
    v_exp_f32 v115, v115
    v_exp_f32 v116, v116
    v_exp_f32 v117, v117
    v_exp_f32 v118, v118
    v_exp_f32 v119, v119
    s_waitcnt vmcnt(2)
    s_xor_b32 s42, s41, 0xc00
    buffer_load_dwordx4 v[144:147], v3, s[12:15], s42 offen nt
    v_cvt_f32_i32 v132, v132
    v_cvt_f32_i32 v133, v133
    v_cvt_f32_i32 v134, v134
    v_cvt_f32_i32 v135, v135
    v_add_f32 v9, v9, v112
    v_add_f32 v9, v9, v113
    v_add_f32 v9, v9, v114
    v_add_f32 v9, v9, v115
    v_add_f32 v9, v9, v116
    v_add_f32 v9, v9, v117
    v_add_f32 v9, v9, v118
    v_add_f32 v9, v9, v119
    s_waitcnt lgkmcnt(0)
    ds_read_b128 v[16:19], v7 offset:768
    ds_read_b128 v[20:23], v7 offset:784
    ds_read_b128 v[24:27], v7 offset:800
    v_mul_f32 v112, v112, v28
    v_mul_f32 v113, v113, v29
    v_mul_f32 v114, v114, v30
    v_mul_f32 v115, v115, v31
    v_mul_f32 v116, v116, v32
    v_mul_f32 v117, v117, v33
    v_mul_f32 v118, v118, v34
    v_mul_f32 v119, v119, v35
    v_cvt_pk_bf16_f32 v48, v112, v113
    v_cvt_pk_bf16_f32 v49, v114, v115
    v_cvt_pk_bf16_f32 v50, v116, v117
    v_cvt_pk_bf16_f32 v51, v118, v119
    v_cvt_pk_bf16_f32 v66, v128, v132
    v_cvt_pk_bf16_f32 v70, v129, v133
    v_cvt_pk_bf16_f32 v74, v130, v134
    v_cvt_pk_bf16_f32 v78, v131, v135
    s_waitcnt vmcnt(2)
    s_xor_b32 s42, s41, 0x1c00
    buffer_load_dwordx4 v[148:151], v3, s[12:15], s42 offen nt
    v_cvt_f32_i32 v136, v136
    v_cvt_f32_i32 v137, v137
    v_cvt_f32_i32 v138, v138
    v_cvt_f32_i32 v139, v139
    v_mfma_f32_16x16x32_bf16 v[12:15], v[36:39], v[48:51], v[12:15]
    v_sub_f32 v120, v120, v8
    v_sub_f32 v121, v121, v8
    v_sub_f32 v122, v122, v8
    v_sub_f32 v123, v123, v8
    v_sub_f32 v124, v124, v8
    v_sub_f32 v125, v125, v8
    v_sub_f32 v126, v126, v8
    v_sub_f32 v127, v127, v8
    v_exp_f32 v120, v120
    v_exp_f32 v121, v121
    v_exp_f32 v122, v122
    v_exp_f32 v123, v123
    v_exp_f32 v124, v124
    v_exp_f32 v125, v125
    v_exp_f32 v126, v126
    v_exp_f32 v127, v127
    s_waitcnt vmcnt(2)
    s_xor_b32 s42, s41, 0xd00
    buffer_load_dwordx4 v[152:155], v3, s[12:15], s42 offen nt
    v_cvt_f32_i32 v140, v140
    v_cvt_f32_i32 v141, v141
    v_cvt_f32_i32 v142, v142
    v_cvt_f32_i32 v143, v143
    v_add_f32 v9, v9, v120
    v_add_f32 v9, v9, v121
    v_add_f32 v9, v9, v122
    v_add_f32 v9, v9, v123
    v_add_f32 v9, v9, v124
    v_add_f32 v9, v9, v125
    v_add_f32 v9, v9, v126
    v_add_f32 v9, v9, v127
    s_waitcnt lgkmcnt(0)
    v_mul_f32 v120, v120, v16
    v_mul_f32 v121, v121, v17
    v_mul_f32 v122, v122, v18
    v_mul_f32 v123, v123, v19
    v_mul_f32 v124, v124, v20
    v_mul_f32 v125, v125, v21
    v_mul_f32 v126, v126, v22
    v_mul_f32 v127, v127, v23
    v_cvt_pk_bf16_f32 v52, v120, v121
    v_cvt_pk_bf16_f32 v53, v122, v123
    v_cvt_pk_bf16_f32 v54, v124, v125
    v_cvt_pk_bf16_f32 v55, v126, v127
    v_cvt_pk_bf16_f32 v82, v136, v140
    v_cvt_pk_bf16_f32 v86, v137, v141
    v_cvt_pk_bf16_f32 v90, v138, v142
    v_cvt_pk_bf16_f32 v94, v139, v143
    s_waitcnt vmcnt(2)
    s_xor_b32 s42, s41, 0x1d00
    buffer_load_dwordx4 v[156:159], v3, s[12:15], s42 offen nt
    v_cvt_f32_i32 v144, v144
    v_cvt_f32_i32 v145, v145
    v_cvt_f32_i32 v146, v146
    v_cvt_f32_i32 v147, v147
    v_mfma_f32_16x16x32_bf16 v[12:15], v[24:27], v[52:55], v[12:15]
    v_mov_b32 v11, v9
    s_nop 1
    v_permlane32_swap_b32 v9, v11
    v_add_f32 v9, v9, v11
    v_mov_b32 v11, v9
    s_nop 1
    v_permlane16_swap_b32 v9, v11
    v_add_f32 v9, v9, v11
    s_waitcnt vmcnt(2)
    s_xor_b32 s42, s41, 0x400000
    buffer_load_dwordx4 v[128:131], v3, s[12:15], s42 offen nt
    v_cvt_f32_i32 v148, v148
    v_cvt_f32_i32 v149, v149
    v_cvt_f32_i32 v150, v150
    v_cvt_f32_i32 v151, v151
    v_cvt_pk_bf16_f32 v67, v144, v148
    v_cvt_pk_bf16_f32 v71, v145, v149
    v_cvt_pk_bf16_f32 v75, v146, v150
    v_cvt_pk_bf16_f32 v79, v147, v151
    s_nop 0
    v_mfma_f32_16x16x32_bf16 v[96:99], v[64:67], v[40:43], 0
    v_mfma_f32_16x16x32_bf16 v[100:103], v[68:71], v[40:43], 0
    v_mfma_f32_16x16x32_bf16 v[104:107], v[72:75], v[40:43], 0
    v_mfma_f32_16x16x32_bf16 v[108:111], v[76:79], v[40:43], 0
    s_waitcnt vmcnt(2)
    s_xor_b32 s42, s41, 0x401000
    buffer_load_dwordx4 v[132:135], v3, s[12:15], s42 offen nt
    v_cvt_f32_i32 v152, v152
    v_cvt_f32_i32 v153, v153
    v_cvt_f32_i32 v154, v154
    v_cvt_f32_i32 v155, v155
    v_mov_b32 v10, v12
    s_mov_b64 exec, 0xff
    ds_write_b96 v162, v[8:10]
    s_mov_b64 exec, 1
    ds_add_u32 v166, v167
    s_mov_b64 exec, -1
    s_waitcnt vmcnt(2)
    s_xor_b32 s42, s41, 0x400100
    buffer_load_dwordx4 v[136:139], v3, s[12:15], s42 offen nt
    v_cvt_f32_i32 v156, v156
    v_cvt_f32_i32 v157, v157
    v_cvt_f32_i32 v158, v158
    v_cvt_f32_i32 v159, v159
    v_cvt_pk_bf16_f32 v83, v152, v156
    v_cvt_pk_bf16_f32 v87, v153, v157
    v_cvt_pk_bf16_f32 v91, v154, v158
    v_cvt_pk_bf16_f32 v95, v155, v159
    s_nop 0
    v_mfma_f32_16x16x32_bf16 v[112:115], v[80:83], v[40:43], 0
    v_mfma_f32_16x16x32_bf16 v[116:119], v[84:87], v[40:43], 0
    v_mfma_f32_16x16x32_bf16 v[120:123], v[88:91], v[40:43], 0
    v_mfma_f32_16x16x32_bf16 v[124:127], v[92:95], v[40:43], 0
    s_waitcnt vmcnt(2)
    s_xor_b32 s42, s41, 0x401100
    buffer_load_dwordx4 v[140:143], v3, s[12:15], s42 offen nt
    v_cvt_f32_i32 v128, v128
    v_cvt_f32_i32 v129, v129
    v_cvt_f32_i32 v130, v130
    v_cvt_f32_i32 v131, v131
    s_waitcnt vmcnt(2)
    s_xor_b32 s42, s41, 0x400800
    buffer_load_dwordx4 v[144:147], v3, s[12:15], s42 offen nt
    v_cvt_f32_i32 v132, v132
    v_cvt_f32_i32 v133, v133
    v_cvt_f32_i32 v134, v134
    v_cvt_f32_i32 v135, v135
    v_cvt_pk_bf16_f32 v64, v128, v132
    v_cvt_pk_bf16_f32 v68, v129, v133
    v_cvt_pk_bf16_f32 v72, v130, v134
    v_cvt_pk_bf16_f32 v76, v131, v135
    s_waitcnt vmcnt(2)
    s_xor_b32 s42, s41, 0x401800
    buffer_load_dwordx4 v[148:151], v3, s[12:15], s42 offen nt
    v_cvt_f32_i32 v136, v136
    v_cvt_f32_i32 v137, v137
    v_cvt_f32_i32 v138, v138
    v_cvt_f32_i32 v139, v139
    s_waitcnt vmcnt(2)
    s_xor_b32 s42, s41, 0x400900
    buffer_load_dwordx4 v[152:155], v3, s[12:15], s42 offen nt
    v_cvt_f32_i32 v140, v140
    v_cvt_f32_i32 v141, v141
    v_cvt_f32_i32 v142, v142
    v_cvt_f32_i32 v143, v143
    v_cvt_pk_bf16_f32 v80, v136, v140
    v_cvt_pk_bf16_f32 v84, v137, v141
    v_cvt_pk_bf16_f32 v88, v138, v142
    v_cvt_pk_bf16_f32 v92, v139, v143
    s_waitcnt vmcnt(2)
    s_xor_b32 s42, s41, 0x401900
    buffer_load_dwordx4 v[156:159], v3, s[12:15], s42 offen nt
    v_cvt_f32_i32 v144, v144
    v_cvt_f32_i32 v145, v145
    v_cvt_f32_i32 v146, v146
    v_cvt_f32_i32 v147, v147
    s_waitcnt vmcnt(2)
    s_xor_b32 s42, s41, 0x400400
    buffer_load_dwordx4 v[128:131], v3, s[12:15], s42 offen nt
    v_cvt_f32_i32 v148, v148
    v_cvt_f32_i32 v149, v149
    v_cvt_f32_i32 v150, v150
    v_cvt_f32_i32 v151, v151
    v_cvt_pk_bf16_f32 v65, v144, v148
    v_cvt_pk_bf16_f32 v69, v145, v149
    v_cvt_pk_bf16_f32 v73, v146, v150
    v_cvt_pk_bf16_f32 v77, v147, v151
    s_waitcnt vmcnt(2)
    s_xor_b32 s42, s41, 0x401400
    buffer_load_dwordx4 v[132:135], v3, s[12:15], s42 offen nt
    v_cvt_f32_i32 v152, v152
    v_cvt_f32_i32 v153, v153
    v_cvt_f32_i32 v154, v154
    v_cvt_f32_i32 v155, v155
    s_waitcnt vmcnt(2)
    s_xor_b32 s42, s41, 0x400500
    buffer_load_dwordx4 v[136:139], v3, s[12:15], s42 offen nt
    v_cvt_f32_i32 v156, v156
    v_cvt_f32_i32 v157, v157
    v_cvt_f32_i32 v158, v158
    v_cvt_f32_i32 v159, v159
    v_cvt_pk_bf16_f32 v81, v152, v156
    v_cvt_pk_bf16_f32 v85, v153, v157
    v_cvt_pk_bf16_f32 v89, v154, v158
    v_cvt_pk_bf16_f32 v93, v155, v159
    s_waitcnt vmcnt(2)
    s_xor_b32 s42, s41, 0x401500
    buffer_load_dwordx4 v[140:143], v3, s[12:15], s42 offen nt
    v_cvt_f32_i32 v128, v128
    v_cvt_f32_i32 v129, v129
    v_cvt_f32_i32 v130, v130
    v_cvt_f32_i32 v131, v131
    s_waitcnt vmcnt(2)
    s_xor_b32 s42, s41, 0x400c00
    buffer_load_dwordx4 v[144:147], v3, s[12:15], s42 offen nt
    v_cvt_f32_i32 v132, v132
    v_cvt_f32_i32 v133, v133
    v_cvt_f32_i32 v134, v134
    v_cvt_f32_i32 v135, v135
    v_cvt_pk_bf16_f32 v66, v128, v132
    v_cvt_pk_bf16_f32 v70, v129, v133
    v_cvt_pk_bf16_f32 v74, v130, v134
    v_cvt_pk_bf16_f32 v78, v131, v135
    s_waitcnt vmcnt(2)
    s_xor_b32 s42, s41, 0x401c00
    buffer_load_dwordx4 v[148:151], v3, s[12:15], s42 offen nt
    v_cvt_f32_i32 v136, v136
    v_cvt_f32_i32 v137, v137
    v_cvt_f32_i32 v138, v138
    v_cvt_f32_i32 v139, v139
    s_waitcnt vmcnt(2)
    s_xor_b32 s42, s41, 0x400d00
    buffer_load_dwordx4 v[152:155], v3, s[12:15], s42 offen nt
    v_cvt_f32_i32 v140, v140
    v_cvt_f32_i32 v141, v141
    v_cvt_f32_i32 v142, v142
    v_cvt_f32_i32 v143, v143
    v_cvt_pk_bf16_f32 v82, v136, v140
    v_cvt_pk_bf16_f32 v86, v137, v141
    v_cvt_pk_bf16_f32 v90, v138, v142
    v_cvt_pk_bf16_f32 v94, v139, v143
    s_waitcnt vmcnt(2)
    s_xor_b32 s42, s41, 0x401d00
    buffer_load_dwordx4 v[156:159], v3, s[12:15], s42 offen nt
    v_cvt_f32_i32 v144, v144
    v_cvt_f32_i32 v145, v145
    v_cvt_f32_i32 v146, v146
    v_cvt_f32_i32 v147, v147
    s_waitcnt vmcnt(2)
    s_xor_b32 s42, s41, 0x800000
    buffer_load_dwordx4 v[128:131], v3, s[12:15], s42 offen nt
    v_cvt_f32_i32 v148, v148
    v_cvt_f32_i32 v149, v149
    v_cvt_f32_i32 v150, v150
    v_cvt_f32_i32 v151, v151
    v_cvt_pk_bf16_f32 v67, v144, v148
    v_cvt_pk_bf16_f32 v71, v145, v149
    v_cvt_pk_bf16_f32 v75, v146, v150
    v_cvt_pk_bf16_f32 v79, v147, v151
    s_nop 0
    v_mfma_f32_16x16x32_bf16 v[96:99], v[64:67], v[44:47], v[96:99]
    v_mfma_f32_16x16x32_bf16 v[100:103], v[68:71], v[44:47], v[100:103]
    v_mfma_f32_16x16x32_bf16 v[104:107], v[72:75], v[44:47], v[104:107]
    v_mfma_f32_16x16x32_bf16 v[108:111], v[76:79], v[44:47], v[108:111]
    s_waitcnt vmcnt(2)
    s_xor_b32 s42, s41, 0x801000
    buffer_load_dwordx4 v[132:135], v3, s[12:15], s42 offen nt
    v_cvt_f32_i32 v152, v152
    v_cvt_f32_i32 v153, v153
    v_cvt_f32_i32 v154, v154
    v_cvt_f32_i32 v155, v155
    s_waitcnt vmcnt(2)
    s_xor_b32 s42, s41, 0x800100
    buffer_load_dwordx4 v[136:139], v3, s[12:15], s42 offen nt
    v_cvt_f32_i32 v156, v156
    v_cvt_f32_i32 v157, v157
    v_cvt_f32_i32 v158, v158
    v_cvt_f32_i32 v159, v159
    v_cvt_pk_bf16_f32 v83, v152, v156
    v_cvt_pk_bf16_f32 v87, v153, v157
    v_cvt_pk_bf16_f32 v91, v154, v158
    v_cvt_pk_bf16_f32 v95, v155, v159
    s_nop 0
    v_mfma_f32_16x16x32_bf16 v[112:115], v[80:83], v[44:47], v[112:115]
    v_mfma_f32_16x16x32_bf16 v[116:119], v[84:87], v[44:47], v[116:119]
    v_mfma_f32_16x16x32_bf16 v[120:123], v[88:91], v[44:47], v[120:123]
    v_mfma_f32_16x16x32_bf16 v[124:127], v[92:95], v[44:47], v[124:127]
    s_waitcnt vmcnt(2)
    s_xor_b32 s42, s41, 0x801100
    buffer_load_dwordx4 v[140:143], v3, s[12:15], s42 offen nt
    v_cvt_f32_i32 v128, v128
    v_cvt_f32_i32 v129, v129
    v_cvt_f32_i32 v130, v130
    v_cvt_f32_i32 v131, v131
    s_waitcnt vmcnt(2)
    s_xor_b32 s42, s41, 0x800800
    buffer_load_dwordx4 v[144:147], v3, s[12:15], s42 offen nt
    v_cvt_f32_i32 v132, v132
    v_cvt_f32_i32 v133, v133
    v_cvt_f32_i32 v134, v134
    v_cvt_f32_i32 v135, v135
    v_cvt_pk_bf16_f32 v64, v128, v132
    v_cvt_pk_bf16_f32 v68, v129, v133
    v_cvt_pk_bf16_f32 v72, v130, v134
    v_cvt_pk_bf16_f32 v76, v131, v135
    s_waitcnt vmcnt(2)
    s_xor_b32 s42, s41, 0x801800
    buffer_load_dwordx4 v[148:151], v3, s[12:15], s42 offen nt
    v_cvt_f32_i32 v136, v136
    v_cvt_f32_i32 v137, v137
    v_cvt_f32_i32 v138, v138
    v_cvt_f32_i32 v139, v139
    s_waitcnt vmcnt(2)
    s_xor_b32 s42, s41, 0x800900
    buffer_load_dwordx4 v[152:155], v3, s[12:15], s42 offen nt
    v_cvt_f32_i32 v140, v140
    v_cvt_f32_i32 v141, v141
    v_cvt_f32_i32 v142, v142
    v_cvt_f32_i32 v143, v143
    v_cvt_pk_bf16_f32 v80, v136, v140
    v_cvt_pk_bf16_f32 v84, v137, v141
    v_cvt_pk_bf16_f32 v88, v138, v142
    v_cvt_pk_bf16_f32 v92, v139, v143
    s_waitcnt vmcnt(2)
    s_xor_b32 s42, s41, 0x801900
    buffer_load_dwordx4 v[156:159], v3, s[12:15], s42 offen nt
    v_cvt_f32_i32 v144, v144
    v_cvt_f32_i32 v145, v145
    v_cvt_f32_i32 v146, v146
    v_cvt_f32_i32 v147, v147
    s_waitcnt vmcnt(2)
    s_xor_b32 s42, s41, 0x800400
    buffer_load_dwordx4 v[128:131], v3, s[12:15], s42 offen nt
    v_cvt_f32_i32 v148, v148
    v_cvt_f32_i32 v149, v149
    v_cvt_f32_i32 v150, v150
    v_cvt_f32_i32 v151, v151
    v_cvt_pk_bf16_f32 v65, v144, v148
    v_cvt_pk_bf16_f32 v69, v145, v149
    v_cvt_pk_bf16_f32 v73, v146, v150
    v_cvt_pk_bf16_f32 v77, v147, v151
    s_waitcnt vmcnt(2)
    s_xor_b32 s42, s41, 0x801400
    buffer_load_dwordx4 v[132:135], v3, s[12:15], s42 offen nt
    v_cvt_f32_i32 v152, v152
    v_cvt_f32_i32 v153, v153
    v_cvt_f32_i32 v154, v154
    v_cvt_f32_i32 v155, v155
    s_waitcnt vmcnt(2)
    s_xor_b32 s42, s41, 0x800500
    buffer_load_dwordx4 v[136:139], v3, s[12:15], s42 offen nt
    v_cvt_f32_i32 v156, v156
    v_cvt_f32_i32 v157, v157
    v_cvt_f32_i32 v158, v158
    v_cvt_f32_i32 v159, v159
    v_cvt_pk_bf16_f32 v81, v152, v156
    v_cvt_pk_bf16_f32 v85, v153, v157
    v_cvt_pk_bf16_f32 v89, v154, v158
    v_cvt_pk_bf16_f32 v93, v155, v159
    s_waitcnt vmcnt(2)
    s_xor_b32 s42, s41, 0x801500
    buffer_load_dwordx4 v[140:143], v3, s[12:15], s42 offen nt
    v_cvt_f32_i32 v128, v128
    v_cvt_f32_i32 v129, v129
    v_cvt_f32_i32 v130, v130
    v_cvt_f32_i32 v131, v131
    s_waitcnt vmcnt(2)
    s_xor_b32 s42, s41, 0x800c00
    buffer_load_dwordx4 v[144:147], v3, s[12:15], s42 offen nt
    v_cvt_f32_i32 v132, v132
    v_cvt_f32_i32 v133, v133
    v_cvt_f32_i32 v134, v134
    v_cvt_f32_i32 v135, v135
    v_cvt_pk_bf16_f32 v66, v128, v132
    v_cvt_pk_bf16_f32 v70, v129, v133
    v_cvt_pk_bf16_f32 v74, v130, v134
    v_cvt_pk_bf16_f32 v78, v131, v135
    s_waitcnt vmcnt(2)
    s_xor_b32 s42, s41, 0x801c00
    buffer_load_dwordx4 v[148:151], v3, s[12:15], s42 offen nt
    v_cvt_f32_i32 v136, v136
    v_cvt_f32_i32 v137, v137
    v_cvt_f32_i32 v138, v138
    v_cvt_f32_i32 v139, v139
    s_waitcnt vmcnt(2)
    s_xor_b32 s42, s41, 0x800d00
    buffer_load_dwordx4 v[152:155], v3, s[12:15], s42 offen nt
    v_cvt_f32_i32 v140, v140
    v_cvt_f32_i32 v141, v141
    v_cvt_f32_i32 v142, v142
    v_cvt_f32_i32 v143, v143
    v_cvt_pk_bf16_f32 v82, v136, v140
    v_cvt_pk_bf16_f32 v86, v137, v141
    v_cvt_pk_bf16_f32 v90, v138, v142
    v_cvt_pk_bf16_f32 v94, v139, v143
    s_waitcnt vmcnt(2)
    s_xor_b32 s42, s41, 0x801d00
    buffer_load_dwordx4 v[156:159], v3, s[12:15], s42 offen nt
    v_cvt_f32_i32 v144, v144
    v_cvt_f32_i32 v145, v145
    v_cvt_f32_i32 v146, v146
    v_cvt_f32_i32 v147, v147
    s_waitcnt vmcnt(2)
    s_xor_b32 s42, s41, 0xc00000
    buffer_load_dwordx4 v[128:131], v3, s[12:15], s42 offen nt
    v_cvt_f32_i32 v148, v148
    v_cvt_f32_i32 v149, v149
    v_cvt_f32_i32 v150, v150
    v_cvt_f32_i32 v151, v151
    v_cvt_pk_bf16_f32 v67, v144, v148
    v_cvt_pk_bf16_f32 v71, v145, v149
    v_cvt_pk_bf16_f32 v75, v146, v150
    v_cvt_pk_bf16_f32 v79, v147, v151
    s_nop 0
    v_mfma_f32_16x16x32_bf16 v[96:99], v[64:67], v[48:51], v[96:99]
    v_mfma_f32_16x16x32_bf16 v[100:103], v[68:71], v[48:51], v[100:103]
    v_mfma_f32_16x16x32_bf16 v[104:107], v[72:75], v[48:51], v[104:107]
    v_mfma_f32_16x16x32_bf16 v[108:111], v[76:79], v[48:51], v[108:111]
    s_waitcnt vmcnt(2)
    s_xor_b32 s42, s41, 0xc01000
    buffer_load_dwordx4 v[132:135], v3, s[12:15], s42 offen nt
    v_cvt_f32_i32 v152, v152
    v_cvt_f32_i32 v153, v153
    v_cvt_f32_i32 v154, v154
    v_cvt_f32_i32 v155, v155
    s_waitcnt vmcnt(2)
    s_xor_b32 s42, s41, 0xc00100
    buffer_load_dwordx4 v[136:139], v3, s[12:15], s42 offen nt
    v_cvt_f32_i32 v156, v156
    v_cvt_f32_i32 v157, v157
    v_cvt_f32_i32 v158, v158
    v_cvt_f32_i32 v159, v159
    v_cvt_pk_bf16_f32 v83, v152, v156
    v_cvt_pk_bf16_f32 v87, v153, v157
    v_cvt_pk_bf16_f32 v91, v154, v158
    v_cvt_pk_bf16_f32 v95, v155, v159
    s_nop 0
    v_mfma_f32_16x16x32_bf16 v[112:115], v[80:83], v[48:51], v[112:115]
    v_mfma_f32_16x16x32_bf16 v[116:119], v[84:87], v[48:51], v[116:119]
    v_mfma_f32_16x16x32_bf16 v[120:123], v[88:91], v[48:51], v[120:123]
    v_mfma_f32_16x16x32_bf16 v[124:127], v[92:95], v[48:51], v[124:127]
    s_waitcnt vmcnt(2)
    s_xor_b32 s42, s41, 0xc01100
    buffer_load_dwordx4 v[140:143], v3, s[12:15], s42 offen nt
    v_cvt_f32_i32 v128, v128
    v_cvt_f32_i32 v129, v129
    v_cvt_f32_i32 v130, v130
    v_cvt_f32_i32 v131, v131
    s_waitcnt vmcnt(2)
    s_xor_b32 s42, s41, 0xc00800
    buffer_load_dwordx4 v[144:147], v3, s[12:15], s42 offen nt
    v_cvt_f32_i32 v132, v132
    v_cvt_f32_i32 v133, v133
    v_cvt_f32_i32 v134, v134
    v_cvt_f32_i32 v135, v135
    v_cvt_pk_bf16_f32 v64, v128, v132
    v_cvt_pk_bf16_f32 v68, v129, v133
    v_cvt_pk_bf16_f32 v72, v130, v134
    v_cvt_pk_bf16_f32 v76, v131, v135
    s_waitcnt vmcnt(2)
    s_xor_b32 s42, s41, 0xc01800
    buffer_load_dwordx4 v[148:151], v3, s[12:15], s42 offen nt
    v_cvt_f32_i32 v136, v136
    v_cvt_f32_i32 v137, v137
    v_cvt_f32_i32 v138, v138
    v_cvt_f32_i32 v139, v139
    s_waitcnt vmcnt(2)
    s_xor_b32 s42, s41, 0xc00900
    buffer_load_dwordx4 v[152:155], v3, s[12:15], s42 offen nt
    v_cvt_f32_i32 v140, v140
    v_cvt_f32_i32 v141, v141
    v_cvt_f32_i32 v142, v142
    v_cvt_f32_i32 v143, v143
    v_cvt_pk_bf16_f32 v80, v136, v140
    v_cvt_pk_bf16_f32 v84, v137, v141
    v_cvt_pk_bf16_f32 v88, v138, v142
    v_cvt_pk_bf16_f32 v92, v139, v143
    s_waitcnt vmcnt(2)
    s_xor_b32 s42, s41, 0xc01900
    buffer_load_dwordx4 v[156:159], v3, s[12:15], s42 offen nt
    v_cvt_f32_i32 v144, v144
    v_cvt_f32_i32 v145, v145
    v_cvt_f32_i32 v146, v146
    v_cvt_f32_i32 v147, v147
    s_waitcnt vmcnt(2)
    s_xor_b32 s42, s41, 0xc00400
    buffer_load_dwordx4 v[128:131], v3, s[12:15], s42 offen nt
    v_cvt_f32_i32 v148, v148
    v_cvt_f32_i32 v149, v149
    v_cvt_f32_i32 v150, v150
    v_cvt_f32_i32 v151, v151
    v_cvt_pk_bf16_f32 v65, v144, v148
    v_cvt_pk_bf16_f32 v69, v145, v149
    v_cvt_pk_bf16_f32 v73, v146, v150
    v_cvt_pk_bf16_f32 v77, v147, v151
    s_waitcnt vmcnt(2)
    s_xor_b32 s42, s41, 0xc01400
    buffer_load_dwordx4 v[132:135], v3, s[12:15], s42 offen nt
    v_cvt_f32_i32 v152, v152
    v_cvt_f32_i32 v153, v153
    v_cvt_f32_i32 v154, v154
    v_cvt_f32_i32 v155, v155
    s_waitcnt vmcnt(2)
    s_xor_b32 s42, s41, 0xc00500
    buffer_load_dwordx4 v[136:139], v3, s[12:15], s42 offen nt
    v_cvt_f32_i32 v156, v156
    v_cvt_f32_i32 v157, v157
    v_cvt_f32_i32 v158, v158
    v_cvt_f32_i32 v159, v159
    v_cvt_pk_bf16_f32 v81, v152, v156
    v_cvt_pk_bf16_f32 v85, v153, v157
    v_cvt_pk_bf16_f32 v89, v154, v158
    v_cvt_pk_bf16_f32 v93, v155, v159
    s_waitcnt vmcnt(2)
    s_xor_b32 s42, s41, 0xc01500
    buffer_load_dwordx4 v[140:143], v3, s[12:15], s42 offen nt
    v_cvt_f32_i32 v128, v128
    v_cvt_f32_i32 v129, v129
    v_cvt_f32_i32 v130, v130
    v_cvt_f32_i32 v131, v131
    s_waitcnt vmcnt(2)
    s_xor_b32 s42, s41, 0xc00c00
    buffer_load_dwordx4 v[144:147], v3, s[12:15], s42 offen nt
    v_cvt_f32_i32 v132, v132
    v_cvt_f32_i32 v133, v133
    v_cvt_f32_i32 v134, v134
    v_cvt_f32_i32 v135, v135
    v_cvt_pk_bf16_f32 v66, v128, v132
    v_cvt_pk_bf16_f32 v70, v129, v133
    v_cvt_pk_bf16_f32 v74, v130, v134
    v_cvt_pk_bf16_f32 v78, v131, v135
    s_waitcnt vmcnt(2)
    s_xor_b32 s42, s41, 0xc01c00
    buffer_load_dwordx4 v[148:151], v3, s[12:15], s42 offen nt
    v_cvt_f32_i32 v136, v136
    v_cvt_f32_i32 v137, v137
    v_cvt_f32_i32 v138, v138
    v_cvt_f32_i32 v139, v139
    s_waitcnt vmcnt(2)
    s_xor_b32 s42, s41, 0xc00d00
    buffer_load_dwordx4 v[152:155], v3, s[12:15], s42 offen nt
    v_cvt_f32_i32 v140, v140
    v_cvt_f32_i32 v141, v141
    v_cvt_f32_i32 v142, v142
    v_cvt_f32_i32 v143, v143
    v_cvt_pk_bf16_f32 v82, v136, v140
    v_cvt_pk_bf16_f32 v86, v137, v141
    v_cvt_pk_bf16_f32 v90, v138, v142
    v_cvt_pk_bf16_f32 v94, v139, v143
    s_waitcnt vmcnt(2)
    s_xor_b32 s42, s41, 0xc01d00
    buffer_load_dwordx4 v[156:159], v3, s[12:15], s42 offen nt
    v_cvt_f32_i32 v144, v144
    v_cvt_f32_i32 v145, v145
    v_cvt_f32_i32 v146, v146
    v_cvt_f32_i32 v147, v147
    s_waitcnt vmcnt(2)
    v_cvt_f32_i32 v148, v148
    v_cvt_f32_i32 v149, v149
    v_cvt_f32_i32 v150, v150
    v_cvt_f32_i32 v151, v151
    s_mov_b64 exec, 1
    ds_add_u32 v166, v167 offset:4
    s_mov_b64 exec, -1
    v_cvt_pk_bf16_f32 v67, v144, v148
    v_cvt_pk_bf16_f32 v71, v145, v149
    v_cvt_pk_bf16_f32 v75, v146, v150
    v_cvt_pk_bf16_f32 v79, v147, v151
    s_nop 0
    v_mfma_f32_16x16x32_bf16 v[96:99], v[64:67], v[52:55], v[96:99]
    v_mfma_f32_16x16x32_bf16 v[100:103], v[68:71], v[52:55], v[100:103]
    v_mfma_f32_16x16x32_bf16 v[104:107], v[72:75], v[52:55], v[104:107]
    v_mfma_f32_16x16x32_bf16 v[108:111], v[76:79], v[52:55], v[108:111]
    s_mov_b32 exec_lo, 0x00ff00ff
    s_mov_b32 exec_hi, 0x00ff00ff
    s_nop 2
    ds_write_b128 v160, v[96:99] offset:0
    ds_write_b128 v160, v[100:103] offset:16
    ds_write_b128 v160, v[104:107] offset:32
    ds_write_b128 v160, v[108:111] offset:48
    s_mov_b64 exec, -1
    s_waitcnt vmcnt(1)
    v_cvt_f32_i32 v152, v152
    v_cvt_f32_i32 v153, v153
    v_cvt_f32_i32 v154, v154
    v_cvt_f32_i32 v155, v155
    s_waitcnt vmcnt(0)
    v_cvt_f32_i32 v156, v156
    v_cvt_f32_i32 v157, v157
    v_cvt_f32_i32 v158, v158
    v_cvt_f32_i32 v159, v159
    v_cvt_pk_bf16_f32 v83, v152, v156
    v_cvt_pk_bf16_f32 v87, v153, v157
    v_cvt_pk_bf16_f32 v91, v154, v158
    v_cvt_pk_bf16_f32 v95, v155, v159
    s_nop 0
    v_mfma_f32_16x16x32_bf16 v[112:115], v[80:83], v[52:55], v[112:115]
    v_mfma_f32_16x16x32_bf16 v[116:119], v[84:87], v[52:55], v[116:119]
    v_mfma_f32_16x16x32_bf16 v[120:123], v[88:91], v[52:55], v[120:123]
    v_mfma_f32_16x16x32_bf16 v[124:127], v[92:95], v[52:55], v[124:127]
    s_mov_b32 exec_lo, 0x00ff00ff
    s_mov_b32 exec_hi, 0x00ff00ff
    s_nop 2
    ds_write_b128 v161, v[112:115] offset:0
    ds_write_b128 v161, v[116:119] offset:16
    ds_write_b128 v161, v[120:123] offset:32
    ds_write_b128 v161, v[124:127] offset:48
    s_mov_b64 exec, -1
    s_waitcnt lgkmcnt(0)
    s_barrier
    s_cmp_ge_u32 s3, 4
    s_cbranch_scc1 L_fin
    ds_read_b128 v[16:19], v164
    ds_read_b128 v[64:67], v163
    ds_read_b32 v24, v164 offset:48
    ds_read_b128 v[20:23], v164 offset:16
    ds_read_b128 v[68:71], v163 offset:9216
    ds_read_b128 v[72:75], v163 offset:18432
    ds_read_b128 v[76:79], v163 offset:27648
    ds_read_b128 v[80:83], v163 offset:36864
    ds_read_b128 v[84:87], v163 offset:46080
    ds_read_b128 v[88:91], v163 offset:55296
    ds_read_b128 v[92:95], v163 offset:64512
    ds_read_b32 v25, v1 offset:32
    s_waitcnt lgkmcnt(9)
    v_fma_f32 v44, v16, v64, -v24
    v_fma_f32 v45, v16, v65, -v24
    v_fma_f32 v46, v16, v66, -v24
    v_fma_f32 v47, v16, v67, -v24
    s_waitcnt lgkmcnt(7)
    v_fmac_f32 v44, v17, v68
    v_fmac_f32 v45, v17, v69
    v_fmac_f32 v46, v17, v70
    v_fmac_f32 v47, v17, v71
    s_waitcnt lgkmcnt(6)
    v_fmac_f32 v44, v18, v72
    v_fmac_f32 v45, v18, v73
    v_fmac_f32 v46, v18, v74
    v_fmac_f32 v47, v18, v75
    s_waitcnt lgkmcnt(5)
    v_fmac_f32 v44, v19, v76
    v_fmac_f32 v45, v19, v77
    v_fmac_f32 v46, v19, v78
    v_fmac_f32 v47, v19, v79
    s_waitcnt lgkmcnt(4)
    v_fmac_f32 v44, v20, v80
    v_fmac_f32 v45, v20, v81
    v_fmac_f32 v46, v20, v82
    v_fmac_f32 v47, v20, v83
    s_waitcnt lgkmcnt(3)
    v_fmac_f32 v44, v21, v84
    v_fmac_f32 v45, v21, v85
    v_fmac_f32 v46, v21, v86
    v_fmac_f32 v47, v21, v87
    s_waitcnt lgkmcnt(2)
    v_fmac_f32 v44, v22, v88
    v_fmac_f32 v45, v22, v89
    v_fmac_f32 v46, v22, v90
    v_fmac_f32 v47, v22, v91
    s_waitcnt lgkmcnt(1)
    v_fmac_f32 v44, v23, v92
    v_fmac_f32 v45, v23, v93
    v_fmac_f32 v46, v23, v94
    v_fmac_f32 v47, v23, v95
    v_perm_b32 v48, v44, v47, s57
    v_perm_b32 v49, v45, v47, s58
    v_perm_b32 v50, v46, v47, s59
    s_waitcnt lgkmcnt(0)
    v_xor_b32 v51, v48, v25
    v_bitop3_b32 v51, v49, v50, v51 bitop3:0x96
    buffer_store_dwordx4 v[48:51], v165, s[52:55], s56 offen sc1
    s_branch L_fin
L_helper:
    s_lshr_b32 s4, s38, 24
    s_bfe_u32 s5, s38, 0x50011
    v_mov_b32 v106, 105984
    v_mov_b32 v4, 0
    v_mov_b32 v5, 0
    ds_write_b64 v106, v[4:5]
    v_lshrrev_b32 v59, 4, v57
    v_lshrrev_b32 v10, 3, v57
    v_and_b32 v11, 7, v57
    v_lshlrev_b32 v107, 4, v57
    v_add_u32 v107, 104448, v107
    v_lshlrev_b32 v108, 6, v10
    v_add_u32 v108, 105472, v108
    v_lshl_add_u32 v109, v11, 2, v108
    v_mul_u32_u24 v101, 4352, v10
    v_lshl_add_u32 v101, v11, 4, v101
    v_lshrrev_b32 v10, 2, v11
    v_lshlrev_b32 v10, 4, v10
    v_lshl_add_u32 v10, v59, 2, v10
    v_and_b32 v12, 3, v11
    v_add_lshl_u32 v103, v10, v12, 1
    v_bfe_u32 v110, v57, 1, 1
    s_mul_i32 s56, s4, 139264
    s_lshl_b32 s37, s5, 7
    s_add_u32 s56, s56, s37
    s_add_u32 s57, s56, 34816
    s_add_u32 s58, s56, 69632
    s_add_u32 s59, s56, 104448
    s_lshl_b32 s65, s4, 11
    s_lshl_b32 s37, s5, 6
    s_add_u32 s65, s65, s37
    s_mov_b32 s54, 1114368
    s_mov_b32 s55, 0x20000
    s_mov_b32 s70, 16384
    s_mov_b32 s71, 0x20000
    s_mov_b32 s73, 1114112
    s_mov_b32 s60, 0x04000c0c
    s_mov_b32 s61, 0x0706000c
    s_waitcnt lgkmcnt(0)
    s_mov_b32 s52, s34
    s_mov_b32 s53, s35
    s_mov_b32 s68, s30
    s_mov_b32 s69, s31
    s_barrier
    s_mov_b64 exec, 1
    s_cmp_lg_u32 s2, 0
    s_cbranch_scc1 L_h_other
    buffer_load_dword v1, v4, s[52:55], s73 offen sc1
    s_waitcnt vmcnt(0)
    v_add_u32 v1, 1, v1
    v_max_u32 v1, 1, v1
    buffer_store_dword v1, v4, s[52:55], s73 offen sc1
    s_waitcnt vmcnt(0)
    global_store_dword v4, v1, s[32:33] sc1
L_h_other:
    s_mov_b32 s67, 1600000
L_h_rec:
    s_sleep 4
    ds_read_b32 v10, v106 offset:0
    s_sub_u32 s67, s67, 1
    s_cbranch_scc1 L_fin
    s_waitcnt lgkmcnt(0)
    v_cmp_ne_u32 vcc, 8, v10
    s_cbranch_vccnz L_h_rec
    s_mov_b32 s67, 400000
L_h_nonce:
    global_load_dword v1, v4, s[32:33] sc1
    s_sub_u32 s67, s67, 1
    s_cbranch_scc1 L_fin
    s_waitcnt vmcnt(0)
    v_readfirstlane_b32 s75, v1
    s_nop 3
    s_cmp_lg_u32 s75, 0
    s_cbranch_scc1 L_h_have
    s_sleep 40
    s_branch L_h_nonce
L_h_have:
    s_mov_b64 exec, -1
    ds_read_b96 v[16:18], v107
    s_lshl_b32 s76, s75, 1
    v_lshlrev_b32 v110, v110, s75
    s_waitcnt lgkmcnt(0)
    v_mov_b32 v12, v16
    s_nop 1
    v_max_f32_dpp v12, v12, v12 quad_perm:[1,0,3,2] row_mask:0xf bank_mask:0xf
    s_nop 1
    v_max_f32_dpp v12, v12, v12 quad_perm:[2,3,0,1] row_mask:0xf bank_mask:0xf
    s_nop 1
    v_max_f32_dpp v12, v12, v12 row_half_mirror row_mask:0xf bank_mask:0xf
    v_sub_f32 v16, v16, v12
    v_exp_f32 v16, v16
    s_nop 0
    v_mul_f32 v13, v16, v17
    v_mul_f32 v14, v16, v18
    ds_write_b32 v109, v16
    s_nop 0
    v_add_f32_dpp v13, v13, v13 quad_perm:[1,0,3,2] row_mask:0xf bank_mask:0xf
    v_add_f32_dpp v14, v14, v14 quad_perm:[1,0,3,2] row_mask:0xf bank_mask:0xf
    s_nop 0
    v_add_f32_dpp v13, v13, v13 quad_perm:[2,3,0,1] row_mask:0xf bank_mask:0xf
    v_add_f32_dpp v14, v14, v14 quad_perm:[2,3,0,1] row_mask:0xf bank_mask:0xf
    s_nop 0
    v_add_f32_dpp v13, v13, v13 row_half_mirror row_mask:0xf bank_mask:0xf
    v_add_f32_dpp v14, v14, v14 row_half_mirror row_mask:0xf bank_mask:0xf
    v_xor_b32 v8, s75, v12
    v_xor_b32 v9, s75, v13
    v_xor_b32 v10, s76, v12
    v_xor_b32 v11, s76, v13
    s_mov_b32 exec_lo, 0x01010101
    s_mov_b32 exec_hi, 0x01010101
    ds_write_b128 v108, v[8:11] offset:32
    ds_write_b32 v108, v14 offset:48
    s_mov_b64 exec, -1
    s_mov_b32 s40, 15
    s_mov_b32 s41, 0x40000000
    s_mov_b32 s67, 1600000
L_h_tick:
    s_sleep 4
    ds_read_b32 v10, v106 offset:4
    s_sub_u32 s67, s67, 1
    s_cbranch_scc1 L_fin
    s_waitcnt lgkmcnt(0)
    v_cmp_eq_u32 vcc, 0, v10
    s_cbranch_vccnz L_h_tick
    s_mov_b32 s67, 400000
    buffer_load_dwordx4 v[24:27], v101, s[52:55], s56 offen sc1
    buffer_load_dwordx4 v[28:31], v101, s[52:55], s57 offen sc1
    buffer_load_dwordx4 v[32:35], v101, s[52:55], s58 offen sc1
    buffer_load_dwordx4 v[36:39], v101, s[52:55], s59 offen sc1
    s_barrier
L_pd:
    buffer_load_dwordx4 v[40:43], v101, s[52:55], s56 offen sc1
    buffer_load_dwordx4 v[44:47], v101, s[52:55], s57 offen sc1
    buffer_load_dwordx4 v[48:51], v101, s[52:55], s58 offen sc1
    buffer_load_dwordx4 v[52:55], v101, s[52:55], s59 offen sc1
    s_waitcnt vmcnt(4)
    s_bitcmp1_b32 s40, 0
    s_cbranch_scc0 L_cka_0
    v_bitop3_b32 v10, v24, v25, v26 bitop3:0x96
    v_bitop3_b32 v68, v10, v27, v110 bitop3:0x96
    v_perm_b32 v11, v24, v25, s60
    v_perm_b32 v67, v11, v26, s61
    v_xor_b32_dpp v10, v68, v68 quad_perm:[2,3,0,1] row_mask:0xf bank_mask:0xf
    v_mov_b32 v64, v24
    v_cmp_ne_u32 vcc, 0, v10
    v_mov_b32 v65, v25
    v_mov_b32 v66, v26
    s_cbranch_vccnz L_cka_0
    s_mov_b32 s56, s41
    s_bitset0_b32 s40, 0
L_cka_0:
    s_bitcmp1_b32 s40, 1
    s_cbranch_scc0 L_cka_1
    v_bitop3_b32 v10, v28, v29, v30 bitop3:0x96
    v_bitop3_b32 v76, v10, v31, v110 bitop3:0x96
    v_perm_b32 v11, v28, v29, s60
    v_perm_b32 v75, v11, v30, s61
    v_xor_b32_dpp v10, v76, v76 quad_perm:[2,3,0,1] row_mask:0xf bank_mask:0xf
    v_mov_b32 v72, v28
    v_cmp_ne_u32 vcc, 0, v10
    v_mov_b32 v73, v29
    v_mov_b32 v74, v30
    s_cbranch_vccnz L_cka_1
    s_mov_b32 s57, s41
    s_bitset0_b32 s40, 1
L_cka_1:
    s_bitcmp1_b32 s40, 2
    s_cbranch_scc0 L_cka_2
    v_bitop3_b32 v10, v32, v33, v34 bitop3:0x96
    v_bitop3_b32 v84, v10, v35, v110 bitop3:0x96
    v_perm_b32 v11, v32, v33, s60
    v_perm_b32 v83, v11, v34, s61
    v_xor_b32_dpp v10, v84, v84 quad_perm:[2,3,0,1] row_mask:0xf bank_mask:0xf
    v_mov_b32 v80, v32
    v_cmp_ne_u32 vcc, 0, v10
    v_mov_b32 v81, v33
    v_mov_b32 v82, v34
    s_cbranch_vccnz L_cka_2
    s_mov_b32 s58, s41
    s_bitset0_b32 s40, 2
L_cka_2:
    s_bitcmp1_b32 s40, 3
    s_cbranch_scc0 L_cka_3
    v_bitop3_b32 v10, v36, v37, v38 bitop3:0x96
    v_bitop3_b32 v92, v10, v39, v110 bitop3:0x96
    v_perm_b32 v11, v36, v37, s60
    v_perm_b32 v91, v11, v38, s61
    v_xor_b32_dpp v10, v92, v92 quad_perm:[2,3,0,1] row_mask:0xf bank_mask:0xf
    v_mov_b32 v88, v36
    v_cmp_ne_u32 vcc, 0, v10
    v_mov_b32 v89, v37
    v_mov_b32 v90, v38
    s_cbranch_vccnz L_cka_3
    s_mov_b32 s59, s41
    s_bitset0_b32 s40, 3
L_cka_3:
    s_cmp_eq_u32 s40, 0
    s_cbranch_scc1 L_pd_done
    buffer_load_dwordx4 v[24:27], v101, s[52:55], s56 offen sc1
    buffer_load_dwordx4 v[28:31], v101, s[52:55], s57 offen sc1
    buffer_load_dwordx4 v[32:35], v101, s[52:55], s58 offen sc1
    buffer_load_dwordx4 v[36:39], v101, s[52:55], s59 offen sc1
    s_waitcnt vmcnt(4)
    s_bitcmp1_b32 s40, 0
    s_cbranch_scc0 L_ckb_0
    v_bitop3_b32 v10, v40, v41, v42 bitop3:0x96
    v_bitop3_b32 v68, v10, v43, v110 bitop3:0x96
    v_perm_b32 v11, v40, v41, s60
    v_perm_b32 v67, v11, v42, s61
    v_xor_b32_dpp v10, v68, v68 quad_perm:[2,3,0,1] row_mask:0xf bank_mask:0xf
    v_mov_b32 v64, v40
    v_cmp_ne_u32 vcc, 0, v10
    v_mov_b32 v65, v41
    v_mov_b32 v66, v42
    s_cbranch_vccnz L_ckb_0
    s_mov_b32 s56, s41
    s_bitset0_b32 s40, 0
L_ckb_0:
    s_bitcmp1_b32 s40, 1
    s_cbranch_scc0 L_ckb_1
    v_bitop3_b32 v10, v44, v45, v46 bitop3:0x96
    v_bitop3_b32 v76, v10, v47, v110 bitop3:0x96
    v_perm_b32 v11, v44, v45, s60
    v_perm_b32 v75, v11, v46, s61
    v_xor_b32_dpp v10, v76, v76 quad_perm:[2,3,0,1] row_mask:0xf bank_mask:0xf
    v_mov_b32 v72, v44
    v_cmp_ne_u32 vcc, 0, v10
    v_mov_b32 v73, v45
    v_mov_b32 v74, v46
    s_cbranch_vccnz L_ckb_1
    s_mov_b32 s57, s41
    s_bitset0_b32 s40, 1
L_ckb_1:
    s_bitcmp1_b32 s40, 2
    s_cbranch_scc0 L_ckb_2
    v_bitop3_b32 v10, v48, v49, v50 bitop3:0x96
    v_bitop3_b32 v84, v10, v51, v110 bitop3:0x96
    v_perm_b32 v11, v48, v49, s60
    v_perm_b32 v83, v11, v50, s61
    v_xor_b32_dpp v10, v84, v84 quad_perm:[2,3,0,1] row_mask:0xf bank_mask:0xf
    v_mov_b32 v80, v48
    v_cmp_ne_u32 vcc, 0, v10
    v_mov_b32 v81, v49
    v_mov_b32 v82, v50
    s_cbranch_vccnz L_ckb_2
    s_mov_b32 s58, s41
    s_bitset0_b32 s40, 2
L_ckb_2:
    s_bitcmp1_b32 s40, 3
    s_cbranch_scc0 L_ckb_3
    v_bitop3_b32 v10, v52, v53, v54 bitop3:0x96
    v_bitop3_b32 v92, v10, v55, v110 bitop3:0x96
    v_perm_b32 v11, v52, v53, s60
    v_perm_b32 v91, v11, v54, s61
    v_xor_b32_dpp v10, v92, v92 quad_perm:[2,3,0,1] row_mask:0xf bank_mask:0xf
    v_mov_b32 v88, v52
    v_cmp_ne_u32 vcc, 0, v10
    v_mov_b32 v89, v53
    v_mov_b32 v90, v54
    s_cbranch_vccnz L_ckb_3
    s_mov_b32 s59, s41
    s_bitset0_b32 s40, 3
L_ckb_3:
    s_cmp_eq_u32 s40, 0
    s_cbranch_scc1 L_pd_done
    s_sub_u32 s67, s67, 1
    s_cbranch_scc0 L_pd
    s_branch L_fin
L_pd_done:
    v_max3_f32 v8, v68, v76, v84
    v_max_f32 v8, v8, v92
    s_nop 1
    v_max_f32_dpp v8, v8, v8 row_ror:8 row_mask:0xf bank_mask:0xf
    v_mov_b32 v9, v8
    s_nop 1
    v_permlane16_swap_b32 v8, v9
    v_max_f32 v8, v8, v9
    v_mov_b32 v9, v8
    s_nop 1
    v_permlane32_swap_b32 v8, v9
    v_max_f32 v8, v8, v9
    s_nop 1
    v_mov_b32_dpp v8, v8 quad_perm:[0,0,2,2] row_mask:0xf bank_mask:0xf
    v_sub_f32_dpp v16, v68, v8 quad_perm:[0,0,2,2] row_mask:0xf bank_mask:0xf
    v_sub_f32_dpp v17, v76, v8 quad_perm:[0,0,2,2] row_mask:0xf bank_mask:0xf
    v_sub_f32_dpp v18, v84, v8 quad_perm:[0,0,2,2] row_mask:0xf bank_mask:0xf
    v_sub_f32_dpp v19, v92, v8 quad_perm:[0,0,2,2] row_mask:0xf bank_mask:0xf
    v_exp_f32 v16, v16
    v_exp_f32 v17, v17
    v_exp_f32 v18, v18
    v_exp_f32 v19, v19
    v_mul_f32 v12, v16, v68
    v_mul_f32 v8, v16, v64
    v_mul_f32 v10, v16, v66
    v_mul_f32 v9, v16, v65
    v_mul_f32 v11, v16, v67
    v_fmac_f32 v12, v17, v76
    v_fmac_f32 v8, v17, v72
    v_fmac_f32 v10, v17, v74
    v_fmac_f32 v9, v17, v73
    v_fmac_f32 v11, v17, v75
    v_fmac_f32 v12, v18, v84
    v_fmac_f32 v8, v18, v80
    v_fmac_f32 v10, v18, v82
    v_fmac_f32 v9, v18, v81
    v_fmac_f32 v11, v18, v83
    v_fmac_f32 v12, v19, v92
    v_fmac_f32 v8, v19, v88
    v_fmac_f32 v10, v19, v90
    v_fmac_f32 v9, v19, v89
    v_fmac_f32 v11, v19, v91
    v_mov_b32 v13, v12
    v_permlane32_swap_b32 v8, v10
    v_permlane32_swap_b32 v9, v11
    v_permlane32_swap_b32 v12, v13
    v_add_f32 v8, v8, v10
    v_add_f32 v9, v9, v11
    v_add_f32 v12, v12, v13
    v_mov_b32 v13, v12
    s_nop 0
    v_permlane16_swap_b32 v8, v9
    v_permlane16_swap_b32 v12, v13
    v_add_f32 v12, v12, v13
    v_add_f32 v8, v8, v9
    s_nop 0
    v_add_f32_dpp v12, v12, v12 row_ror:8 row_mask:0xf bank_mask:0xf
    v_add_f32_dpp v8, v8, v8 row_ror:8 row_mask:0xf bank_mask:0xf
    s_nop 0
    v_rcp_f32_dpp v12, v12 quad_perm:[1,1,3,3] row_mask:0xf bank_mask:0xf
    s_mov_b32 exec_lo, 0x00ff00ff
    s_mov_b32 exec_hi, 0x00ff00ff
    v_mul_f32 v8, v8, v12
    v_cvt_pk_bf16_f32 v8, v8, v8
    buffer_store_short v8, v103, s[68:71], s65 offen
L_fin:
L_done:
    s_endpgm
.section .rodata,"a"
.p2align 6
.amdhsa_kernel standalone__kv_cache_quant_int4_int2_kv_with_per_channel_or_per_token_scales__decode_kernel
  .amdhsa_next_free_vgpr 168
  .amdhsa_next_free_sgpr 80
  .amdhsa_accum_offset 168
  .amdhsa_group_segment_fixed_size 0
  .amdhsa_kernarg_size 80
  .amdhsa_user_sgpr_count 2
  .amdhsa_user_sgpr_kernarg_segment_ptr 1
  .amdhsa_system_sgpr_workgroup_id_x 1
.end_amdhsa_kernel
```
